```python
import torch

def _softmax(x, axis=-1):
    return torch.softmax(x, dim=axis)
def _gelu(x):
    return torch.nn.functional.gelu(x, approximate="tanh")
def _silu(x):
    return torch.nn.functional.silu(x)
def _sigmoid(x):
    return torch.sigmoid(x)
def _layernorm(x, axis=-1, eps=1e-5):
    m = x.mean(dim=axis, keepdim=True)
    v = x.var(dim=axis, keepdim=True, unbiased=False)
    return (x - m) / torch.sqrt(v + eps)
def _scatter_add(tgt, idx, src, axis=0):
    return tgt.clone().index_add_(axis, idx, src)
def _segment_sum(src, seg, n):
    out = torch.zeros((n,) + src.shape[1:], dtype=src.dtype)
    return out.index_add_(0, seg, src)
def _pad(x, pw):
    flat = tuple(v for pair in reversed(pw) for v in pair)
    return torch.nn.functional.pad(x, flat)

kernel_name = 'standalone__gqa_block_cached__decode'

def setup_inputs():

    _w = (lambda a: (lambda t: t.to(torch.bfloat16) if t.is_floating_point() else t)(torch.as_tensor(a)))
    B, Sq, D = 8, 1, 640
    Hq, Hkv, Sk, Dh = 32, 32, 4096, 192
    assert Hq % Hkv == 0, (Hq, Hkv)
    return {
        "x": _w((lambda *s: torch.randn(*s, dtype=torch.bfloat16) * 0.8)(B, Sq, D)),
        "k_cache": _w((lambda *s: torch.randn(*s, dtype=torch.bfloat16) * 0.8)(B, Hkv, Sk, Dh)),
        "v_cache": _w((lambda *s: torch.randn(*s, dtype=torch.bfloat16) * 0.05)(B, Hkv, Sk, Dh)),
        "wq": _w((lambda *s: torch.randn(*s, dtype=torch.bfloat16) * 0.8)(D, Hq * Dh) * (D ** -0.5)),
        "wo": _w((lambda *s: torch.randn(*s, dtype=torch.bfloat16) * 0.05)(Hq * Dh, D) * ((Hq * Dh) ** -0.5)),
    }

def reference(x, k_cache, v_cache, wq, wo):
    B, Sq, D = x.shape
    Hq, Dh = 32, 192
    Hkv = k_cache.shape[1]
    rep = Hq // Hkv
    q = (lambda x, *d: x.permute(*d))((x @ wq).reshape(B, Sq, Hq, Dh), 0, 2, 1, 3)
    k = (lambda x, n, axis: torch.repeat_interleave(x, n, dim=axis))(k_cache, rep, axis=1)
    v = (lambda x, n, axis: torch.repeat_interleave(x, n, dim=axis))(v_cache, rep, axis=1)
    scores = torch.einsum("bhqd,bhkd->bhqk", q, k) * (Dh ** -0.5)
    p = _softmax(scores, axis=-1)
    o = torch.einsum("bhqk,bhkd->bhqd", p, v)
    return (lambda x, *d: x.permute(*d))(o, 0, 2, 1, 3).reshape(B, Sq, Hq * Dh) @ wo
```

```asm
; @launch grid=(256,1,1) block=(640,1,1) lds=162560
.amdgcn_target "amdgcn-amd-amdhsa--gfx950"
.text
.globl standalone__gqa_block_cached__decode_kernel
.p2align 8
.type standalone__gqa_block_cached__decode_kernel,@function
standalone__gqa_block_cached__decode_kernel:
  s_cmp_ge_u32 s2, 256
  s_cbranch_scc1 L_end
  s_load_dwordx16 s[36:51], s[0:1], 0
  v_lshrrev_b32 v1, 6, v0
  v_and_b32 v0, 63, v0
  v_readfirstlane_b32 s3, v1
  s_and_b32 s5, s2, 31
  s_lshr_b32 s4, s2, 5
  s_mov_b32 s11, 0x20000
  s_cmp_lg_u32 s3, 0
  s_cbranch_scc1 L_cons
  s_setprio 3
  v_lshlrev_b32 v2, 4, v0
  v_add_u32 v3, 0x8000, v2
  v_add_u32 v4, 0x2000, v2
  v_add_u32 v5, 0xa000, v2
  s_mul_i32 s6, s2, 1572864
  s_mov_b32 s10, 1572864
  s_mov_b32 s56, 0
  s_mov_b32 s57, 0
  s_mov_b32 s58, 0x8000
  s_mov_b32 s59, 0
  s_mov_b32 s60, 0
  s_mov_b32 s61, 5
  s_movk_i32 s62, 0x2000
  s_mov_b32 s63, 0xa000
  s_mov_b32 s66, 147456
  s_getpc_b64 s[30:31]
L_pc0:
  s_add_u32 s30, s30, L_seg1-L_pc0
  s_addc_u32 s31, s31, 0
  s_waitcnt lgkmcnt(0)
  s_add_u32 s8, s38, s6
  s_addc_u32 s9, s39, 0
L_ld:
  s_mov_b32 m0, s57
  s_waitcnt vmcnt(19)
  s_bitcmp1_b32 s60, s59
  s_cbranch_scc0 L_ld_nb
  s_barrier
L_ld_nb:
  buffer_load_dwordx4 v2, s[8:11], s56 offen nt lds
  s_mov_b32 m0, s58
  s_waitcnt vmcnt(19)
  buffer_load_dwordx4 v3, s[8:11], s56 offen nt lds
  s_add_u32 m0, s57, s62
  s_waitcnt vmcnt(19)
  buffer_load_dwordx4 v4, s[8:11], s56 offen nt lds
  s_add_u32 m0, s58, s62
  s_waitcnt vmcnt(19)
  buffer_load_dwordx4 v5, s[8:11], s56 offen nt lds
  s_or_b32 s64, s56, s63
  s_addk_i32 s64, 0x400
  s_andn2_b32 s64, s64, s63
  s_sub_u32 s65, s64, s56
  s_mov_b32 s56, s64
  s_add_u32 s57, s57, s65
  s_sub_u32 s64, s57, s66
  s_cselect_b32 s57, s57, s64
  s_add_u32 s58, s58, s65
  s_sub_u32 s64, s58, s66
  s_cselect_b32 s58, s58, s64
  s_add_u32 s59, s59, 1
  s_cmp_lg_u32 s59, s61
  s_cbranch_scc1 L_ld
  s_setpc_b64 s[30:31]
L_seg1:
  s_add_u32 s20, s50, 4194304
  s_addc_u32 s21, s51, 0
  s_mov_b32 s22, 69632
  s_mov_b32 s23, 0x20000
  s_getreg_b32 s32, hwreg(HW_REG_XCC_ID, 0, 4)
  s_mul_i32 s32, s32, 4352
  s_getreg_b32 s35, hwreg(HW_REG_HW_ID, 8, 4)
  s_getreg_b32 s7, hwreg(HW_REG_HW_ID, 13, 2)
  s_lshl_b32 s7, s7, 4
  s_add_u32 s35, s35, s7
  v_lshlrev_b32 v11, 2, v0
  buffer_load_dword v9, v11, s[20:23], s32 offen
  s_lshl_b64 s[18:19], 1, s35
  s_mov_b32 s33, 0
  s_mov_b32 s34, 0
  s_mov_b32 s24, 285212672
  s_mov_b32 s25, 1430532898
  s_mov_b32 s16, 2575857510
  s_mov_b32 s17, 2863311530
  s_mov_b32 s12, 2863311528
  s_mov_b32 s13, 10922
  s_lshl_b64 s[14:15], s[12:13], 1
  s_movk_i32 s61, 28
  s_call_b64 s[30:31], L_ld
  s_barrier
  s_mov_b32 s60, 4259905
  s_movk_i32 s61, 48
  s_call_b64 s[30:31], L_ld
  s_getpc_b64 s[28:29]
L_pcf:
  s_add_u32 s28, s28, L_f0-L_pcf
  s_addc_u32 s29, s29, 0
  s_add_u32 s30, s28, L_f5-L_f0
  s_addc_u32 s31, s29, 0
  s_branch L_ctl
L_f0:
  s_mov_b32 m0, s57
  s_waitcnt vmcnt(14)
  s_bitcmp1_b32 s60, s59
  s_cbranch_scc0 L_f0_nb
  s_barrier
L_f0_nb:
  buffer_load_dwordx4 v2, s[8:11], s56 offen nt lds
  s_mov_b32 m0, s58
  s_waitcnt vmcnt(14)
  buffer_load_dwordx4 v3, s[8:11], s56 offen nt lds
  s_add_u32 m0, s57, s62
  s_waitcnt vmcnt(14)
  buffer_load_dwordx4 v4, s[8:11], s56 offen nt lds
  s_add_u32 m0, s58, s62
  s_waitcnt vmcnt(14)
  buffer_load_dwordx4 v5, s[8:11], s56 offen nt lds
  s_or_b32 s64, s56, s63
  s_addk_i32 s64, 0x400
  s_andn2_b32 s64, s64, s63
  s_sub_u32 s65, s64, s56
  s_mov_b32 s56, s64
  s_add_u32 s57, s57, s65
  s_sub_u32 s64, s57, s66
  s_cselect_b32 s57, s57, s64
  s_add_u32 s58, s58, s65
  s_sub_u32 s64, s58, s66
  s_cselect_b32 s58, s58, s64
  s_add_u32 s59, s59, 1
  s_cmp_lg_u32 s59, s61
  s_cbranch_scc1 L_f0
  s_branch L_ctl
L_f1:
  s_mov_b32 m0, s57
  s_waitcnt vmcnt(15)
  s_bitcmp1_b32 s60, s59
  s_cbranch_scc0 L_f1_nb
  s_barrier
L_f1_nb:
  buffer_load_dwordx4 v2, s[8:11], s56 offen nt lds
  s_mov_b32 m0, s58
  s_waitcnt vmcnt(15)
  buffer_load_dwordx4 v3, s[8:11], s56 offen nt lds
  s_add_u32 m0, s57, s62
  s_waitcnt vmcnt(15)
  buffer_load_dwordx4 v4, s[8:11], s56 offen nt lds
  s_add_u32 m0, s58, s62
  s_waitcnt vmcnt(15)
  buffer_load_dwordx4 v5, s[8:11], s56 offen nt lds
  s_or_b32 s64, s56, s63
  s_addk_i32 s64, 0x400
  s_andn2_b32 s64, s64, s63
  s_sub_u32 s65, s64, s56
  s_mov_b32 s56, s64
  s_add_u32 s57, s57, s65
  s_sub_u32 s64, s57, s66
  s_cselect_b32 s57, s57, s64
  s_add_u32 s58, s58, s65
  s_sub_u32 s64, s58, s66
  s_cselect_b32 s58, s58, s64
  s_add_u32 s59, s59, 1
  s_cmp_lg_u32 s59, s61
  s_cbranch_scc1 L_f1
  s_branch L_ctl
L_f2:
  s_mov_b32 m0, s57
  s_waitcnt vmcnt(16)
  s_bitcmp1_b32 s60, s59
  s_cbranch_scc0 L_f2_nb
  s_barrier
L_f2_nb:
  buffer_load_dwordx4 v2, s[8:11], s56 offen nt lds
  s_mov_b32 m0, s58
  s_waitcnt vmcnt(16)
  buffer_load_dwordx4 v3, s[8:11], s56 offen nt lds
  s_add_u32 m0, s57, s62
  s_waitcnt vmcnt(16)
  buffer_load_dwordx4 v4, s[8:11], s56 offen nt lds
  s_add_u32 m0, s58, s62
  s_waitcnt vmcnt(16)
  buffer_load_dwordx4 v5, s[8:11], s56 offen nt lds
  s_or_b32 s64, s56, s63
  s_addk_i32 s64, 0x400
  s_andn2_b32 s64, s64, s63
  s_sub_u32 s65, s64, s56
  s_mov_b32 s56, s64
  s_add_u32 s57, s57, s65
  s_sub_u32 s64, s57, s66
  s_cselect_b32 s57, s57, s64
  s_add_u32 s58, s58, s65
  s_sub_u32 s64, s58, s66
  s_cselect_b32 s58, s58, s64
  s_add_u32 s59, s59, 1
  s_cmp_lg_u32 s59, s61
  s_cbranch_scc1 L_f2
  s_branch L_ctl
L_f3:
  s_mov_b32 m0, s57
  s_waitcnt vmcnt(17)
  s_bitcmp1_b32 s60, s59
  s_cbranch_scc0 L_f3_nb
  s_barrier
L_f3_nb:
  buffer_load_dwordx4 v2, s[8:11], s56 offen nt lds
  s_mov_b32 m0, s58
  s_waitcnt vmcnt(17)
  buffer_load_dwordx4 v3, s[8:11], s56 offen nt lds
  s_add_u32 m0, s57, s62
  s_waitcnt vmcnt(17)
  buffer_load_dwordx4 v4, s[8:11], s56 offen nt lds
  s_add_u32 m0, s58, s62
  s_waitcnt vmcnt(17)
  buffer_load_dwordx4 v5, s[8:11], s56 offen nt lds
  s_or_b32 s64, s56, s63
  s_addk_i32 s64, 0x400
  s_andn2_b32 s64, s64, s63
  s_sub_u32 s65, s64, s56
  s_mov_b32 s56, s64
  s_add_u32 s57, s57, s65
  s_sub_u32 s64, s57, s66
  s_cselect_b32 s57, s57, s64
  s_add_u32 s58, s58, s65
  s_sub_u32 s64, s58, s66
  s_cselect_b32 s58, s58, s64
  s_add_u32 s59, s59, 1
  s_cmp_lg_u32 s59, s61
  s_cbranch_scc1 L_f3
  s_branch L_ctl
L_f4:
  s_mov_b32 m0, s57
  s_waitcnt vmcnt(18)
  s_bitcmp1_b32 s60, s59
  s_cbranch_scc0 L_f4_nb
  s_barrier
L_f4_nb:
  buffer_load_dwordx4 v2, s[8:11], s56 offen nt lds
  s_mov_b32 m0, s58
  s_waitcnt vmcnt(18)
  buffer_load_dwordx4 v3, s[8:11], s56 offen nt lds
  s_add_u32 m0, s57, s62
  s_waitcnt vmcnt(18)
  buffer_load_dwordx4 v4, s[8:11], s56 offen nt lds
  s_add_u32 m0, s58, s62
  s_waitcnt vmcnt(18)
  buffer_load_dwordx4 v5, s[8:11], s56 offen nt lds
  s_or_b32 s64, s56, s63
  s_addk_i32 s64, 0x400
  s_andn2_b32 s64, s64, s63
  s_sub_u32 s65, s64, s56
  s_mov_b32 s56, s64
  s_add_u32 s57, s57, s65
  s_sub_u32 s64, s57, s66
  s_cselect_b32 s57, s57, s64
  s_add_u32 s58, s58, s65
  s_sub_u32 s64, s58, s66
  s_cselect_b32 s58, s58, s64
  s_add_u32 s59, s59, 1
  s_cmp_lg_u32 s59, s61
  s_cbranch_scc1 L_f4
  s_branch L_ctl
L_f5:
  s_mov_b32 m0, s57
  s_waitcnt vmcnt(19)
  s_bitcmp1_b32 s60, s59
  s_cbranch_scc0 L_f5_nb
  s_barrier
L_f5_nb:
  buffer_load_dwordx4 v2, s[8:11], s56 offen nt lds
  s_mov_b32 m0, s58
  s_waitcnt vmcnt(19)
  buffer_load_dwordx4 v3, s[8:11], s56 offen nt lds
  s_add_u32 m0, s57, s62
  s_waitcnt vmcnt(19)
  buffer_load_dwordx4 v4, s[8:11], s56 offen nt lds
  s_add_u32 m0, s58, s62
  s_waitcnt vmcnt(19)
  buffer_load_dwordx4 v5, s[8:11], s56 offen nt lds
  s_or_b32 s64, s56, s63
  s_addk_i32 s64, 0x400
  s_andn2_b32 s64, s64, s63
  s_sub_u32 s65, s64, s56
  s_mov_b32 s56, s64
  s_add_u32 s57, s57, s65
  s_sub_u32 s64, s57, s66
  s_cselect_b32 s57, s57, s64
  s_add_u32 s58, s58, s65
  s_sub_u32 s64, s58, s66
  s_cselect_b32 s58, s58, s64
  s_add_u32 s59, s59, 1
  s_cmp_lg_u32 s59, s61
  s_cbranch_scc1 L_f5
  s_branch L_ctl
L_f6:
  s_mov_b32 m0, s57
  s_waitcnt vmcnt(20)
  s_bitcmp1_b32 s60, s59
  s_cbranch_scc0 L_f6_nb
  s_barrier
L_f6_nb:
  buffer_load_dwordx4 v2, s[8:11], s56 offen nt lds
  s_mov_b32 m0, s58
  s_waitcnt vmcnt(20)
  buffer_load_dwordx4 v3, s[8:11], s56 offen nt lds
  s_add_u32 m0, s57, s62
  s_waitcnt vmcnt(20)
  buffer_load_dwordx4 v4, s[8:11], s56 offen nt lds
  s_add_u32 m0, s58, s62
  s_waitcnt vmcnt(20)
  buffer_load_dwordx4 v5, s[8:11], s56 offen nt lds
  s_or_b32 s64, s56, s63
  s_addk_i32 s64, 0x400
  s_andn2_b32 s64, s64, s63
  s_sub_u32 s65, s64, s56
  s_mov_b32 s56, s64
  s_add_u32 s57, s57, s65
  s_sub_u32 s64, s57, s66
  s_cselect_b32 s57, s57, s64
  s_add_u32 s58, s58, s65
  s_sub_u32 s64, s58, s66
  s_cselect_b32 s58, s58, s64
  s_add_u32 s59, s59, 1
  s_cmp_lg_u32 s59, s61
  s_cbranch_scc1 L_f6
  s_branch L_ctl
L_f7:
  s_mov_b32 m0, s57
  s_waitcnt vmcnt(21)
  s_bitcmp1_b32 s60, s59
  s_cbranch_scc0 L_f7_nb
  s_barrier
L_f7_nb:
  buffer_load_dwordx4 v2, s[8:11], s56 offen nt lds
  s_mov_b32 m0, s58
  s_waitcnt vmcnt(21)
  buffer_load_dwordx4 v3, s[8:11], s56 offen nt lds
  s_add_u32 m0, s57, s62
  s_waitcnt vmcnt(21)
  buffer_load_dwordx4 v4, s[8:11], s56 offen nt lds
  s_add_u32 m0, s58, s62
  s_waitcnt vmcnt(21)
  buffer_load_dwordx4 v5, s[8:11], s56 offen nt lds
  s_or_b32 s64, s56, s63
  s_addk_i32 s64, 0x400
  s_andn2_b32 s64, s64, s63
  s_sub_u32 s65, s64, s56
  s_mov_b32 s56, s64
  s_add_u32 s57, s57, s65
  s_sub_u32 s64, s57, s66
  s_cselect_b32 s57, s57, s64
  s_add_u32 s58, s58, s65
  s_sub_u32 s64, s58, s66
  s_cselect_b32 s58, s58, s64
  s_add_u32 s59, s59, 1
  s_cmp_lg_u32 s59, s61
  s_cbranch_scc1 L_f7
  s_branch L_ctl
L_f8:
  s_mov_b32 m0, s57
  s_waitcnt vmcnt(22)
  s_bitcmp1_b32 s60, s59
  s_cbranch_scc0 L_f8_nb
  s_barrier
L_f8_nb:
  buffer_load_dwordx4 v2, s[8:11], s56 offen nt lds
  s_mov_b32 m0, s58
  s_waitcnt vmcnt(22)
  buffer_load_dwordx4 v3, s[8:11], s56 offen nt lds
  s_add_u32 m0, s57, s62
  s_waitcnt vmcnt(22)
  buffer_load_dwordx4 v4, s[8:11], s56 offen nt lds
  s_add_u32 m0, s58, s62
  s_waitcnt vmcnt(22)
  buffer_load_dwordx4 v5, s[8:11], s56 offen nt lds
  s_or_b32 s64, s56, s63
  s_addk_i32 s64, 0x400
  s_andn2_b32 s64, s64, s63
  s_sub_u32 s65, s64, s56
  s_mov_b32 s56, s64
  s_add_u32 s57, s57, s65
  s_sub_u32 s64, s57, s66
  s_cselect_b32 s57, s57, s64
  s_add_u32 s58, s58, s65
  s_sub_u32 s64, s58, s66
  s_cselect_b32 s58, s58, s64
  s_add_u32 s59, s59, 1
  s_cmp_lg_u32 s59, s61
  s_cbranch_scc1 L_f8
  s_branch L_ctl
L_f9:
  s_mov_b32 m0, s57
  s_waitcnt vmcnt(23)
  s_bitcmp1_b32 s60, s59
  s_cbranch_scc0 L_f9_nb
  s_barrier
L_f9_nb:
  buffer_load_dwordx4 v2, s[8:11], s56 offen nt lds
  s_mov_b32 m0, s58
  s_waitcnt vmcnt(23)
  buffer_load_dwordx4 v3, s[8:11], s56 offen nt lds
  s_add_u32 m0, s57, s62
  s_waitcnt vmcnt(23)
  buffer_load_dwordx4 v4, s[8:11], s56 offen nt lds
  s_add_u32 m0, s58, s62
  s_waitcnt vmcnt(23)
  buffer_load_dwordx4 v5, s[8:11], s56 offen nt lds
  s_or_b32 s64, s56, s63
  s_addk_i32 s64, 0x400
  s_andn2_b32 s64, s64, s63
  s_sub_u32 s65, s64, s56
  s_mov_b32 s56, s64
  s_add_u32 s57, s57, s65
  s_sub_u32 s64, s57, s66
  s_cselect_b32 s57, s57, s64
  s_add_u32 s58, s58, s65
  s_sub_u32 s64, s58, s66
  s_cselect_b32 s58, s58, s64
  s_add_u32 s59, s59, 1
  s_cmp_lg_u32 s59, s61
  s_cbranch_scc1 L_f9
  s_branch L_ctl
L_f10:
  s_mov_b32 m0, s57
  s_waitcnt vmcnt(24)
  s_bitcmp1_b32 s60, s59
  s_cbranch_scc0 L_f10_nb
  s_barrier
L_f10_nb:
  buffer_load_dwordx4 v2, s[8:11], s56 offen nt lds
  s_mov_b32 m0, s58
  s_waitcnt vmcnt(24)
  buffer_load_dwordx4 v3, s[8:11], s56 offen nt lds
  s_add_u32 m0, s57, s62
  s_waitcnt vmcnt(24)
  buffer_load_dwordx4 v4, s[8:11], s56 offen nt lds
  s_add_u32 m0, s58, s62
  s_waitcnt vmcnt(24)
  buffer_load_dwordx4 v5, s[8:11], s56 offen nt lds
  s_or_b32 s64, s56, s63
  s_addk_i32 s64, 0x400
  s_andn2_b32 s64, s64, s63
  s_sub_u32 s65, s64, s56
  s_mov_b32 s56, s64
  s_add_u32 s57, s57, s65
  s_sub_u32 s64, s57, s66
  s_cselect_b32 s57, s57, s64
  s_add_u32 s58, s58, s65
  s_sub_u32 s64, s58, s66
  s_cselect_b32 s58, s58, s64
  s_add_u32 s59, s59, 1
  s_cmp_lg_u32 s59, s61
  s_cbranch_scc1 L_f10
  s_branch L_ctl
L_ctl:
  s_add_u32 s61, s61, 16
  s_cmp_lg_u32 s59, 384
  s_cbranch_scc1 L_c1
  s_add_u32 s8, s40, s6
  s_addc_u32 s9, s41, 0
  s_mov_b32 s56, 0
L_c1:
  s_cmp_eq_u32 s59, 752
  s_cbranch_scc1 L_d3
  s_lshr_b32 s64, s59, 4
  s_bitcmp0_b64 s[14:15], s64
  s_cbranch_scc1 L_c2
  v_sub_u32 v10, v10, v8
  s_bitset0_b64 exec, 15
  v_cmp_le_i32 vcc, -1, v10
  v_cmp_le_i32 s[30:31], 0, v10
  s_bcnt1_i32_b64 s27, vcc
  v_cmp_le_i32 vcc, 1, v10
  s_bcnt1_i32_b64 s7, s[30:31]
  s_min_u32 s27, s27, 32
  s_add_u32 s27, s27, s7
  s_bcnt1_i32_b64 s7, vcc
  s_add_u32 s27, s27, s7
  v_readlane_b32 s7, v10, 15
  s_mov_b64 exec, -1
  s_add_u32 s27, s27, s33
  s_add_u32 s27, s27, s7
  s_lshl_b32 s27, s27, 1
  s_addk_i32 s27, -95
  s_ashr_i32 s7, s34, 3
  s_sub_i32 s34, s34, s7
  s_mul_i32 s7, s27, 1
  s_add_i32 s34, s34, s7
  s_max_i32 s34, s34, -640
  s_min_i32 s34, s34, 640
  s_cmp_ge_u32 s64, 32
  s_cselect_b32 s7, 6, 1
  s_mul_i32 s27, s27, s7
  s_add_i32 s27, s27, s34
  s_ashr_i32 s27, s27, 6
  s_addk_i32 s27, 16
  s_max_i32 s27, s27, 0
  s_min_i32 s27, s27, 31
  s_cmp_lt_u32 s27, 16
  s_cselect_b64 s[30:31], s[24:25], s[16:17]
  s_lshl_b32 s27, s27, 2
  s_lshr_b64 s[30:31], s[30:31], s27
  s_and_b32 s27, s30, 15
  s_mul_i32 s27, s27, L_f1-L_f0
  s_add_u32 s30, s28, s27
  s_addc_u32 s31, s29, 0
L_c2:
  s_bitcmp0_b64 s[12:13], s64
  s_cbranch_scc1 L_c3
  s_add_u32 s33, s33, 1
  v_add_u32 v8, s33, v9
  buffer_load_dword v10, v11, s[20:23], s32 offen
  s_mov_b64 exec, s[18:19]
  buffer_store_dword v8, v11, s[20:23], s32 offen
  s_mov_b64 exec, -1
L_c3:
  s_setpc_b64 s[30:31]
L_d3:
  s_mov_b32 s57, 131072
  s_mov_b32 s20, s48
  s_mov_b32 s21, s49
  s_movk_i32 s22, 256
  s_mov_b32 s23, 0x20000
  s_lshl_b32 s7, s4, 5
  buffer_load_dword v8, off, s[20:23], s7 sc1
  s_barrier
  s_add_u32 s27, s28, L_f6-L_f0
  s_cmp_lt_u32 s30, s27
  s_cbranch_scc1 L_lsx
  v_add_u32 v3, 8192, v2
  v_add_u32 v4, 4096, v2
  v_add_u32 v5, 12288, v2
L_lsl:
  s_mov_b32 m0, s57
  s_waitcnt vmcnt(31)
  buffer_load_dwordx4 v2, s[8:11], s56 offen nt lds
  s_add_u32 m0, s57, 8192
  s_waitcnt vmcnt(31)
  buffer_load_dwordx4 v3, s[8:11], s56 offen nt lds
  s_add_u32 m0, s57, 4096
  s_waitcnt vmcnt(31)
  buffer_load_dwordx4 v4, s[8:11], s56 offen nt lds
  s_add_u32 m0, s57, 12288
  s_waitcnt vmcnt(31)
  buffer_load_dwordx4 v5, s[8:11], s56 offen nt lds
  s_addk_i32 s56, 0x400
  s_addk_i32 s57, 0x400
  s_cmp_lg_u32 s57, 135168
  s_cbranch_scc1 L_lsl
  v_add_u32 v3, 24576, v2
  v_add_u32 v4, 12288, v2
  v_add_u32 v5, 36864, v2
  s_mov_b32 s57, 0
  s_mov_b32 s59, 0
  s_addk_i32 s56, 0x3000
L_lh:
  s_mov_b32 m0, s57
  s_waitcnt vmcnt(31)
  s_bitcmp1_b32 1040, s59
  s_cbranch_scc0 L_lh_nb
  s_barrier
L_lh_nb:
  buffer_load_dwordx4 v2, s[8:11], s56 offen nt lds
  s_add_u32 m0, s57, 24576
  s_waitcnt vmcnt(31)
  buffer_load_dwordx4 v3, s[8:11], s56 offen nt lds
  s_add_u32 m0, s57, 12288
  s_waitcnt vmcnt(31)
  buffer_load_dwordx4 v4, s[8:11], s56 offen nt lds
  s_add_u32 m0, s57, 36864
  s_waitcnt vmcnt(31)
  buffer_load_dwordx4 v5, s[8:11], s56 offen nt lds
  s_bitcmp1_b32 260, s59
  s_movk_i32 s64, 1024
  s_cmovk_i32 s64, 4096
  s_cmp_eq_u32 s59, 5
  s_cmovk_i32 s64, -5120
  s_add_u32 s57, s57, s64
  s_add_u32 s56, s56, s64
  s_add_u32 s59, s59, 1
  s_cmp_lg_u32 s59, 12
  s_cbranch_scc1 L_lh
  s_branch L_lend
L_lsx:
  v_add_u32 v3, 8192, v2
  v_add_u32 v4, 4096, v2
  v_add_u32 v5, 12288, v2
L_lslx:
  s_mov_b32 m0, s57
  s_waitcnt vmcnt(23)
  buffer_load_dwordx4 v2, s[8:11], s56 offen nt lds
  s_add_u32 m0, s57, 8192
  s_waitcnt vmcnt(23)
  buffer_load_dwordx4 v3, s[8:11], s56 offen nt lds
  s_add_u32 m0, s57, 4096
  s_waitcnt vmcnt(23)
  buffer_load_dwordx4 v4, s[8:11], s56 offen nt lds
  s_add_u32 m0, s57, 12288
  s_waitcnt vmcnt(23)
  buffer_load_dwordx4 v5, s[8:11], s56 offen nt lds
  s_addk_i32 s56, 0x400
  s_addk_i32 s57, 0x400
  s_cmp_lg_u32 s57, 135168
  s_cbranch_scc1 L_lslx
  v_add_u32 v3, 24576, v2
  v_add_u32 v4, 12288, v2
  v_add_u32 v5, 36864, v2
  s_mov_b32 s57, 0
  s_mov_b32 s59, 0
  s_addk_i32 s56, 0x3000
L_lhx:
  s_mov_b32 m0, s57
  s_waitcnt vmcnt(23)
  s_bitcmp1_b32 1040, s59
  s_cbranch_scc0 L_lh_nbx
  s_barrier
L_lh_nbx:
  buffer_load_dwordx4 v2, s[8:11], s56 offen nt lds
  s_add_u32 m0, s57, 24576
  s_waitcnt vmcnt(23)
  buffer_load_dwordx4 v3, s[8:11], s56 offen nt lds
  s_add_u32 m0, s57, 12288
  s_waitcnt vmcnt(23)
  buffer_load_dwordx4 v4, s[8:11], s56 offen nt lds
  s_add_u32 m0, s57, 36864
  s_waitcnt vmcnt(23)
  buffer_load_dwordx4 v5, s[8:11], s56 offen nt lds
  s_bitcmp1_b32 260, s59
  s_movk_i32 s64, 1024
  s_cmovk_i32 s64, 4096
  s_cmp_eq_u32 s59, 5
  s_cmovk_i32 s64, -5120
  s_add_u32 s57, s57, s64
  s_add_u32 s56, s56, s64
  s_add_u32 s59, s59, 1
  s_cmp_lg_u32 s59, 12
  s_cbranch_scc1 L_lhx
L_lend:
  s_waitcnt vmcnt(24)
  s_barrier
  s_waitcnt vmcnt(0)
  s_barrier
  v_readfirstlane_b32 s5, v8
  s_cmp_ge_u32 s5, 0x10000
  s_cbranch_scc0 L_slow
L_slowret:
  s_barrier
  s_barrier
  s_branch L_fin
L_cons:
  s_cmp_eq_u32 s3, 9
  s_cbranch_scc1 L_mon
  s_sub_u32 s3, s3, 1
  v_and_b32 v2, 7, v0
  v_lshrrev_b32 v8, 2, v0
  v_and_b32 v9, 3, v0
  v_lshrrev_b32 v10, 4, v0
  v_mul_u32_u24 v40, 0x3000, v8
  v_lshl_add_u32 v40, v9, 4, v40
  v_mul_u32_u24 v41, 1280, v2
  v_lshl_add_u32 v41, v10, 3, v41
  v_mul_u32_u24 v42, 81920, v2
  v_and_b32 v11, 8, v0
  v_lshl_add_u32 v42, v11, 3, v42
  v_lshl_add_u32 v42, v10, 4, v42
  v_lshrrev_b32 v40, 3, v0
  v_mul_u32_u24 v40, 0x3000, v40
  v_lshl_add_u32 v40, v2, 4, v40
  s_mul_i32 s35, s5, 384
  s_mul_i32 s34, s4, 3
  s_and_b32 s7, s34, 7
  s_mul_i32 s87, s7, 983040
  s_mul_i32 s90, s7, 160
  s_lshr_b32 s7, s34, 3
  s_lshl_b32 s7, s7, 7
  s_add_u32 s7, s7, s35
  s_add_u32 s87, s87, s7
  s_add_u32 s34, s34, 1
  s_and_b32 s7, s34, 7
  s_mul_i32 s88, s7, 983040
  s_lshr_b32 s7, s34, 3
  s_lshl_b32 s7, s7, 7
  s_add_u32 s7, s7, s35
  s_add_u32 s88, s88, s7
  s_add_u32 s34, s34, 1
  s_and_b32 s7, s34, 7
  s_mul_i32 s89, s7, 983040
  s_lshr_b32 s7, s34, 3
  s_lshl_b32 s7, s7, 7
  s_add_u32 s7, s7, s35
  s_add_u32 s89, s89, s7
  v_and_b32 v41, 31, v0
  v_lshl_add_u32 v41, v41, 4, s90
  v_subrev_u32 v43, 1280, v41
  v_min_u32 v41, v41, v43
  v_lshrrev_b32 v43, 5, v0
  v_mul_u32_u24 v43, 1280, v43
  v_add_u32 v41, v41, v43
  s_mov_b32 s66, 131072
  s_movk_i32 s14, 10240
  s_mov_b32 s15, 0x20000
  s_mov_b32 s10, 7864320
  s_mov_b32 m0, 126976
  s_mov_b32 s7, 0
  s_waitcnt lgkmcnt(0)
  s_mov_b32 s12, s36
  s_mov_b32 s13, s37
  s_mov_b32 s8, s42
  s_mov_b32 s9, s43
  s_cmp_ge_u32 s3, 1
  s_cbranch_scc1 L_noprod0
  buffer_load_dwordx4 v41, s[12:15], s7 offen lds
  s_add_u32 m0, m0, 0x400
  s_addk_i32 s7, 2560
  buffer_load_dwordx4 v41, s[12:15], s7 offen lds
  s_add_u32 m0, m0, 0x400
  s_addk_i32 s7, 2560
  buffer_load_dwordx4 v41, s[12:15], s7 offen lds
  s_add_u32 m0, m0, 0x400
  s_addk_i32 s7, 2560
  buffer_load_dwordx4 v41, s[12:15], s7 offen lds
  s_add_u32 m0, m0, 0x400
  s_addk_i32 s7, 2560
  buffer_load_dwordx4 v40, s[8:11], s87 offen  lds
  s_add_u32 m0, m0, 0x400
  s_add_u32 s87, s87, 98304
  buffer_load_dwordx4 v40, s[8:11], s87 offen  lds
  s_add_u32 m0, m0, 0x400
  s_add_u32 s87, s87, 98304
  buffer_load_dwordx4 v40, s[8:11], s87 offen  lds
  s_add_u32 m0, m0, 0x400
  s_add_u32 s87, s87, 98304
  buffer_load_dwordx4 v40, s[8:11], s87 offen  lds
  s_add_u32 m0, m0, 0x400
  s_add_u32 s87, s87, 98304
  buffer_load_dwordx4 v40, s[8:11], s87 offen  lds
  s_add_u32 m0, m0, 0x400
  s_add_u32 s87, s87, 98304
  buffer_load_dwordx4 v40, s[8:11], s87 offen  lds
  s_add_u32 m0, m0, 0x400
  s_add_u32 s87, s87, 98304
  buffer_load_dwordx4 v40, s[8:11], s87 offen  lds
  s_add_u32 m0, m0, 0x400
  s_add_u32 s87, s87, 98304
  buffer_load_dwordx4 v40, s[8:11], s87 offen  lds
  s_add_u32 m0, m0, 0x400
  s_add_u32 s87, s87, 98304
  buffer_load_dwordx4 v40, s[8:11], s87 offen  lds
  s_add_u32 m0, m0, 0x400
  s_add_u32 s87, s87, 98304
  buffer_load_dwordx4 v40, s[8:11], s87 offen  lds
  s_add_u32 m0, m0, 0x400
  s_nop 0
  buffer_load_dwordx4 v40, s[8:11], s88 offen  lds
  s_add_u32 m0, m0, 0x400
  s_add_u32 s88, s88, 98304
  buffer_load_dwordx4 v40, s[8:11], s88 offen  lds
  s_add_u32 m0, m0, 0x400
  s_add_u32 s88, s88, 98304
  buffer_load_dwordx4 v40, s[8:11], s88 offen  lds
  s_add_u32 m0, m0, 0x400
  s_add_u32 s88, s88, 98304
  buffer_load_dwordx4 v40, s[8:11], s88 offen  lds
  s_add_u32 m0, m0, 0x400
  s_add_u32 s88, s88, 98304
  buffer_load_dwordx4 v40, s[8:11], s88 offen  lds
  s_add_u32 m0, m0, 0x400
  s_add_u32 s88, s88, 98304
  buffer_load_dwordx4 v40, s[8:11], s88 offen  lds
  s_add_u32 m0, m0, 0x400
  s_add_u32 s88, s88, 98304
  buffer_load_dwordx4 v40, s[8:11], s88 offen  lds
  s_add_u32 m0, m0, 0x400
  s_add_u32 s88, s88, 98304
  buffer_load_dwordx4 v40, s[8:11], s88 offen  lds
  s_add_u32 m0, m0, 0x400
  s_add_u32 s88, s88, 98304
  buffer_load_dwordx4 v40, s[8:11], s88 offen  lds
  s_add_u32 m0, m0, 0x400
  s_add_u32 s88, s88, 98304
  buffer_load_dwordx4 v40, s[8:11], s88 offen  lds
  s_add_u32 m0, m0, 0x400
  s_nop 0
  buffer_load_dwordx4 v40, s[8:11], s89 offen  lds
  s_add_u32 m0, m0, 0x400
  s_add_u32 s89, s89, 98304
  buffer_load_dwordx4 v40, s[8:11], s89 offen  lds
  s_add_u32 m0, m0, 0x400
  s_add_u32 s89, s89, 98304
  buffer_load_dwordx4 v40, s[8:11], s89 offen  lds
  s_add_u32 m0, m0, 0x400
  s_add_u32 s89, s89, 98304
  buffer_load_dwordx4 v40, s[8:11], s89 offen  lds
  s_add_u32 m0, m0, 0x400
  s_add_u32 s89, s89, 98304
  buffer_load_dwordx4 v40, s[8:11], s89 offen  lds
  s_add_u32 m0, m0, 0x400
  s_add_u32 s89, s89, 98304
  buffer_load_dwordx4 v40, s[8:11], s89 offen  lds
  s_add_u32 m0, m0, 0x400
  s_add_u32 s89, s89, 98304
  buffer_load_dwordx4 v40, s[8:11], s89 offen  lds
  s_add_u32 m0, m0, 0x400
  s_add_u32 s89, s89, 98304
  buffer_load_dwordx4 v40, s[8:11], s89 offen  lds
  s_add_u32 m0, m0, 0x400
  s_add_u32 s89, s89, 98304
  buffer_load_dwordx4 v40, s[8:11], s89 offen  lds
  s_add_u32 m0, m0, 0x400
  s_add_u32 s89, s89, 98304
  buffer_load_dwordx4 v40, s[8:11], s89 offen  lds
  s_cmp_gt_u32 s4, 2
  s_addc_u32 s35, s4, 0
  s_cmp_gt_u32 s4, 5
  s_addc_u32 s35, s35, 0
  s_lshl_b32 s35, s35, 8
  s_mul_i32 s7, s5, 2560
  s_add_u32 s35, s35, s7
L_noprod0:
  s_add_u32 s52, s50, 2097152
  s_addc_u32 s53, s51, 0
  s_mov_b32 s54, 1581056
  s_mov_b32 s55, 0x20000
  s_lshl_b32 s68, s5, 8
  s_add_u32 s68, s68, 1572864
  s_cmp_lg_u32 s3, 6
  s_cbranch_scc1 L_nopre
  buffer_load_dword v47, off, s[52:55], s68 sc1
L_nopre:
  s_movk_i32 s22, 256
  s_mov_b32 s23, 0x20000
  s_mov_b32 s20, s48
  s_mov_b32 s21, s49
  s_xor_b32 s61, s3, 7
  s_or_b32 s61, s61, s5
  s_lshl_b32 s63, s4, 5
  v_mov_b32 v46, 1
  s_cmp_lg_u32 s61, 0
  s_cbranch_scc1 L_noclaim
  s_mov_b64 exec, 1
  buffer_atomic_add v46, off, s[20:23], s63 sc0
  s_mov_b64 exec, -1
L_noclaim:
  v_lshrrev_b32 v1, 3, v0
  v_lshlrev_b32 v39, 4, v0
  v_and_b32 v35, 1, v0
  v_lshlrev_b32 v36, 4, v35
  v_lshlrev_b32 v36, v36, 1
  v_lshrrev_b32 v37, 1, v2
  v_cmp_eq_u32 vcc, 0, v37
  s_nop 1
  v_cndmask_b32 v4, 0, v36, vcc
  v_cmp_eq_u32 vcc, 1, v37
  s_nop 1
  v_cndmask_b32 v5, 0, v36, vcc
  v_cmp_eq_u32 vcc, 2, v37
  s_nop 1
  v_cndmask_b32 v6, 0, v36, vcc
  v_cmp_eq_u32 vcc, 3, v37
  s_nop 1
  v_cndmask_b32 v7, 0, v36, vcc
  s_mov_b32 s24, 0x22222222
  s_mov_b32 s25, s24
  s_mov_b32 s26, 0x44444444
  s_mov_b32 s27, s26
  s_mov_b32 s28, 0x88888888
  s_mov_b32 s29, s28
  s_mov_b32 s30, 0x00f0000f
  s_mov_b32 s31, 0xf0000f00
  s_mov_b32 s32, 0x00ff00ff
  s_mov_b32 s33, 0xff00ff00
  s_lshl_b32 s62, s3, 10
  s_add_u32 s62, s62, 147456
  v_lshlrev_b32 v8, 7, v8
  v_lshl_add_u32 v8, v9, 3, v8
  v_add_u32 v8, s66, v8
  s_add_u32 s16, s50, 1048576
  s_addc_u32 s17, s51, 0
  s_mov_b32 s18, 40960
  s_mov_b32 s19, 0x20000
  s_mul_i32 s64, s4, 5120
  v_and_b32 v24, 15, v0
  v_lshrrev_b32 v26, 1, v24
  v_xor_b32 v25, v10, v26
  v_lshlrev_b32 v25, 4, v25
  v_mul_u32_u24 v26, 384, v24
  v_add_u32 v26, v26, v25
  v_xor_b32 v27, 64, v26
  v_add_u32 v28, 161792, v25
  v_xor_b32 v29, 64, v28
  v_lshlrev_b32 v31, 2, v2
  v_bfe_u32 v32, v0, 3, 1
  v_lshl_add_u32 v31, v32, 1, v31
  v_add_u32 v31, s62, v31
  s_mul_i32 s56, s3, 6144
  v_add_u32 v32, s56, v26
  v_add_u32 v33, s56, v27
  s_mov_b32 s65, 0x3d93cd3a
  s_cmp_ge_u32 s3, 1
  s_cbranch_scc1 L_noprod2
  s_mov_b32 vcc_lo, s33
  s_mov_b32 vcc_hi, s33
  v_lshlrev_b32 v41, 9, v2
  v_lshl_add_u32 v41, v10, 3, v41
  v_add_u32 v41, 126976, v41
  s_waitcnt vmcnt(30)
  ds_read_b64 v[72:73], v41 offset:0
  ds_read_b64 v[74:75], v41 offset:32
  ds_read_b64 v[76:77], v41 offset:64
  ds_read_b64 v[78:79], v41 offset:96
  ds_read_b64 v[80:81], v41 offset:128
  ds_read_b64 v[82:83], v41 offset:160
  ds_read_b64 v[84:85], v41 offset:192
  ds_read_b64 v[86:87], v41 offset:224
  ds_read_b64 v[88:89], v41 offset:256
  ds_read_b64 v[90:91], v41 offset:288
  ds_read_b64 v[92:93], v41 offset:320
  ds_read_b64 v[94:95], v41 offset:352
  ds_read_b64 v[96:97], v41 offset:384
  ds_read_b64 v[98:99], v41 offset:416
  ds_read_b64 v[100:101], v41 offset:448
  s_waitcnt vmcnt(0) lgkmcnt(0)
  ds_read_b64_tr_b16 v[136:137], v8 offset:0
  ds_read_b64_tr_b16 v[138:139], v8 offset:32
  ds_read_b64_tr_b16 v[140:141], v8 offset:64
  ds_read_b64_tr_b16 v[142:143], v8 offset:96
  ds_read_b64_tr_b16 v[144:145], v8 offset:2048
  ds_read_b64_tr_b16 v[146:147], v8 offset:2080
  ds_read_b64_tr_b16 v[148:149], v8 offset:2112
  ds_read_b64_tr_b16 v[150:151], v8 offset:2144
  ds_read_b64_tr_b16 v[152:153], v8 offset:4096
  ds_read_b64_tr_b16 v[154:155], v8 offset:4128
  ds_read_b64_tr_b16 v[156:157], v8 offset:4160
  ds_read_b64_tr_b16 v[158:159], v8 offset:4192
  s_waitcnt lgkmcnt(8)
  v_mfma_f32_16x16x16_bf16 v[48:51], v[136:137], v[72:73], 0
  v_mfma_f32_16x16x16_bf16 v[52:55], v[138:139], v[72:73], 0
  v_mfma_f32_16x16x16_bf16 v[56:59], v[140:141], v[72:73], 0
  v_mfma_f32_16x16x16_bf16 v[60:63], v[142:143], v[72:73], 0
  ds_read_b64_tr_b16 v[160:161], v8 offset:6144
  ds_read_b64_tr_b16 v[162:163], v8 offset:6176
  ds_read_b64_tr_b16 v[164:165], v8 offset:6208
  ds_read_b64_tr_b16 v[166:167], v8 offset:6240
  s_waitcnt lgkmcnt(8)
  v_mfma_f32_16x16x16_bf16 v[48:51], v[144:145], v[74:75], v[48:51]
  v_mfma_f32_16x16x16_bf16 v[52:55], v[146:147], v[74:75], v[52:55]
  v_mfma_f32_16x16x16_bf16 v[56:59], v[148:149], v[74:75], v[56:59]
  v_mfma_f32_16x16x16_bf16 v[60:63], v[150:151], v[74:75], v[60:63]
  ds_read_b64_tr_b16 v[136:137], v8 offset:8192
  ds_read_b64_tr_b16 v[138:139], v8 offset:8224
  ds_read_b64_tr_b16 v[140:141], v8 offset:8256
  ds_read_b64_tr_b16 v[142:143], v8 offset:8288
  s_waitcnt lgkmcnt(8)
  v_mfma_f32_16x16x16_bf16 v[48:51], v[152:153], v[76:77], v[48:51]
  v_mfma_f32_16x16x16_bf16 v[52:55], v[154:155], v[76:77], v[52:55]
  v_mfma_f32_16x16x16_bf16 v[56:59], v[156:157], v[76:77], v[56:59]
  v_mfma_f32_16x16x16_bf16 v[60:63], v[158:159], v[76:77], v[60:63]
  ds_read_b64_tr_b16 v[144:145], v8 offset:10240
  ds_read_b64_tr_b16 v[146:147], v8 offset:10272
  ds_read_b64_tr_b16 v[148:149], v8 offset:10304
  ds_read_b64_tr_b16 v[150:151], v8 offset:10336
  s_waitcnt lgkmcnt(8)
  v_mfma_f32_16x16x16_bf16 v[48:51], v[160:161], v[78:79], v[48:51]
  v_mfma_f32_16x16x16_bf16 v[52:55], v[162:163], v[78:79], v[52:55]
  v_mfma_f32_16x16x16_bf16 v[56:59], v[164:165], v[78:79], v[56:59]
  v_mfma_f32_16x16x16_bf16 v[60:63], v[166:167], v[78:79], v[60:63]
  ds_read_b64_tr_b16 v[152:153], v8 offset:12288
  ds_read_b64_tr_b16 v[154:155], v8 offset:12320
  ds_read_b64_tr_b16 v[156:157], v8 offset:12352
  ds_read_b64_tr_b16 v[158:159], v8 offset:12384
  s_waitcnt lgkmcnt(8)
  v_mfma_f32_16x16x16_bf16 v[48:51], v[136:137], v[80:81], v[48:51]
  v_mfma_f32_16x16x16_bf16 v[52:55], v[138:139], v[80:81], v[52:55]
  v_mfma_f32_16x16x16_bf16 v[56:59], v[140:141], v[80:81], v[56:59]
  v_mfma_f32_16x16x16_bf16 v[60:63], v[142:143], v[80:81], v[60:63]
  ds_read_b64_tr_b16 v[160:161], v8 offset:14336
  ds_read_b64_tr_b16 v[162:163], v8 offset:14368
  ds_read_b64_tr_b16 v[164:165], v8 offset:14400
  ds_read_b64_tr_b16 v[166:167], v8 offset:14432
  s_waitcnt lgkmcnt(8)
  v_mfma_f32_16x16x16_bf16 v[104:107], v[144:145], v[82:83], 0
  v_mfma_f32_16x16x16_bf16 v[108:111], v[146:147], v[82:83], 0
  v_mfma_f32_16x16x16_bf16 v[112:115], v[148:149], v[82:83], 0
  v_mfma_f32_16x16x16_bf16 v[116:119], v[150:151], v[82:83], 0
  ds_read_b64_tr_b16 v[136:137], v8 offset:16384
  ds_read_b64_tr_b16 v[138:139], v8 offset:16416
  ds_read_b64_tr_b16 v[140:141], v8 offset:16448
  ds_read_b64_tr_b16 v[142:143], v8 offset:16480
  s_waitcnt lgkmcnt(8)
  v_mfma_f32_16x16x16_bf16 v[104:107], v[152:153], v[84:85], v[104:107]
  v_mfma_f32_16x16x16_bf16 v[108:111], v[154:155], v[84:85], v[108:111]
  v_mfma_f32_16x16x16_bf16 v[112:115], v[156:157], v[84:85], v[112:115]
  v_mfma_f32_16x16x16_bf16 v[116:119], v[158:159], v[84:85], v[116:119]
  ds_read_b64_tr_b16 v[144:145], v8 offset:18432
  ds_read_b64_tr_b16 v[146:147], v8 offset:18464
  ds_read_b64_tr_b16 v[148:149], v8 offset:18496
  ds_read_b64_tr_b16 v[150:151], v8 offset:18528
  s_waitcnt lgkmcnt(8)
  v_mfma_f32_16x16x16_bf16 v[104:107], v[160:161], v[86:87], v[104:107]
  v_mfma_f32_16x16x16_bf16 v[108:111], v[162:163], v[86:87], v[108:111]
  v_mfma_f32_16x16x16_bf16 v[112:115], v[164:165], v[86:87], v[112:115]
  v_mfma_f32_16x16x16_bf16 v[116:119], v[166:167], v[86:87], v[116:119]
  ds_read_b64_tr_b16 v[152:153], v8 offset:20480
  ds_read_b64_tr_b16 v[154:155], v8 offset:20512
  ds_read_b64_tr_b16 v[156:157], v8 offset:20544
  ds_read_b64_tr_b16 v[158:159], v8 offset:20576
  s_waitcnt lgkmcnt(8)
  v_mfma_f32_16x16x16_bf16 v[104:107], v[136:137], v[88:89], v[104:107]
  v_mfma_f32_16x16x16_bf16 v[108:111], v[138:139], v[88:89], v[108:111]
  v_mfma_f32_16x16x16_bf16 v[112:115], v[140:141], v[88:89], v[112:115]
  v_mfma_f32_16x16x16_bf16 v[116:119], v[142:143], v[88:89], v[116:119]
  ds_read_b64_tr_b16 v[160:161], v8 offset:22528
  ds_read_b64_tr_b16 v[162:163], v8 offset:22560
  ds_read_b64_tr_b16 v[164:165], v8 offset:22592
  ds_read_b64_tr_b16 v[166:167], v8 offset:22624
  s_waitcnt lgkmcnt(8)
  v_mfma_f32_16x16x16_bf16 v[104:107], v[144:145], v[90:91], v[104:107]
  v_mfma_f32_16x16x16_bf16 v[108:111], v[146:147], v[90:91], v[108:111]
  v_mfma_f32_16x16x16_bf16 v[112:115], v[148:149], v[90:91], v[112:115]
  v_mfma_f32_16x16x16_bf16 v[116:119], v[150:151], v[90:91], v[116:119]
  ds_read_b64_tr_b16 v[136:137], v8 offset:24576
  ds_read_b64_tr_b16 v[138:139], v8 offset:24608
  ds_read_b64_tr_b16 v[140:141], v8 offset:24640
  ds_read_b64_tr_b16 v[142:143], v8 offset:24672
  s_waitcnt lgkmcnt(8)
  v_mfma_f32_16x16x16_bf16 v[120:123], v[152:153], v[92:93], 0
  v_mfma_f32_16x16x16_bf16 v[124:127], v[154:155], v[92:93], 0
  v_mfma_f32_16x16x16_bf16 v[128:131], v[156:157], v[92:93], 0
  v_mfma_f32_16x16x16_bf16 v[132:135], v[158:159], v[92:93], 0
  ds_read_b64_tr_b16 v[144:145], v8 offset:26624
  ds_read_b64_tr_b16 v[146:147], v8 offset:26656
  ds_read_b64_tr_b16 v[148:149], v8 offset:26688
  ds_read_b64_tr_b16 v[150:151], v8 offset:26720
  s_waitcnt lgkmcnt(8)
  v_mfma_f32_16x16x16_bf16 v[120:123], v[160:161], v[94:95], v[120:123]
  v_mfma_f32_16x16x16_bf16 v[124:127], v[162:163], v[94:95], v[124:127]
  v_mfma_f32_16x16x16_bf16 v[128:131], v[164:165], v[94:95], v[128:131]
  v_mfma_f32_16x16x16_bf16 v[132:135], v[166:167], v[94:95], v[132:135]
  ds_read_b64_tr_b16 v[152:153], v8 offset:28672
  ds_read_b64_tr_b16 v[154:155], v8 offset:28704
  ds_read_b64_tr_b16 v[156:157], v8 offset:28736
  ds_read_b64_tr_b16 v[158:159], v8 offset:28768
  s_waitcnt lgkmcnt(8)
  v_mfma_f32_16x16x16_bf16 v[120:123], v[136:137], v[96:97], v[120:123]
  v_mfma_f32_16x16x16_bf16 v[124:127], v[138:139], v[96:97], v[124:127]
  v_mfma_f32_16x16x16_bf16 v[128:131], v[140:141], v[96:97], v[128:131]
  v_mfma_f32_16x16x16_bf16 v[132:135], v[142:143], v[96:97], v[132:135]
  s_waitcnt lgkmcnt(4)
  v_mfma_f32_16x16x16_bf16 v[120:123], v[144:145], v[98:99], v[120:123]
  v_mfma_f32_16x16x16_bf16 v[124:127], v[146:147], v[98:99], v[124:127]
  v_mfma_f32_16x16x16_bf16 v[128:131], v[148:149], v[98:99], v[128:131]
  v_mfma_f32_16x16x16_bf16 v[132:135], v[150:151], v[98:99], v[132:135]
  s_waitcnt lgkmcnt(0)
  v_mfma_f32_16x16x16_bf16 v[120:123], v[152:153], v[100:101], v[120:123]
  v_mfma_f32_16x16x16_bf16 v[124:127], v[154:155], v[100:101], v[124:127]
  v_mfma_f32_16x16x16_bf16 v[128:131], v[156:157], v[100:101], v[128:131]
  v_mfma_f32_16x16x16_bf16 v[132:135], v[158:159], v[100:101], v[132:135]
  v_cndmask_b32 v48, v48, v52, vcc
  v_cndmask_b32 v49, v49, v53, vcc
  v_cndmask_b32 v50, v50, v54, vcc
  v_cndmask_b32 v51, v51, v55, vcc
  v_cndmask_b32 v52, v56, v60, vcc
  v_cndmask_b32 v53, v57, v61, vcc
  v_cndmask_b32 v54, v58, v62, vcc
  v_cndmask_b32 v55, v59, v63, vcc
  v_cndmask_b32 v104, v104, v108, vcc
  v_cndmask_b32 v105, v105, v109, vcc
  v_cndmask_b32 v106, v106, v110, vcc
  v_cndmask_b32 v107, v107, v111, vcc
  v_cndmask_b32 v108, v112, v116, vcc
  v_cndmask_b32 v109, v113, v117, vcc
  v_cndmask_b32 v110, v114, v118, vcc
  v_cndmask_b32 v111, v115, v119, vcc
  v_cndmask_b32 v120, v120, v124, vcc
  v_cndmask_b32 v121, v121, v125, vcc
  v_cndmask_b32 v122, v122, v126, vcc
  v_cndmask_b32 v123, v123, v127, vcc
  v_cndmask_b32 v124, v128, v132, vcc
  v_cndmask_b32 v125, v129, v133, vcc
  v_cndmask_b32 v126, v130, v134, vcc
  v_cndmask_b32 v127, v131, v135, vcc
  s_cmp_eq_u32 s4, 5
  s_cbranch_scc1 L_u5
  v_pk_add_f32 v[48:49], v[48:49], v[104:105]
  v_pk_add_f32 v[50:51], v[50:51], v[106:107]
  v_pk_add_f32 v[52:53], v[52:53], v[108:109]
  v_pk_add_f32 v[54:55], v[54:55], v[110:111]
  s_cmp_eq_u32 s4, 2
  s_cbranch_scc1 L_u2
  v_pk_add_f32 v[48:49], v[48:49], v[120:121]
  v_pk_add_f32 v[50:51], v[50:51], v[122:123]
  v_pk_add_f32 v[52:53], v[52:53], v[124:125]
  v_pk_add_f32 v[54:55], v[54:55], v[126:127]
  s_branch L_u0
L_u5:
  v_pk_add_f32 v[120:121], v[120:121], v[104:105]
  v_pk_add_f32 v[122:123], v[122:123], v[106:107]
  v_pk_add_f32 v[124:125], v[124:125], v[108:109]
  v_pk_add_f32 v[126:127], v[126:127], v[110:111]
L_u2:
  buffer_store_dwordx4 v[120:123], v42, s[52:55], s35 offen offset:256 sc1
  buffer_store_dwordx4 v[124:127], v42, s[52:55], s35 offen offset:384 sc1
L_u0:
  buffer_store_dwordx4 v[48:51], v42, s[52:55], s35 offen sc1
  buffer_store_dwordx4 v[52:55], v42, s[52:55], s35 offen offset:128 sc1
  s_branch L_park
L_noprod2:
  s_waitcnt vmcnt(0)
  v_readfirstlane_b32 s61, v46
  s_cmp_lg_u32 s61, 0
  s_cbranch_scc1 L_park
  v_mov_b32 v40, 0
  v_mov_b32 v41, 0
  v_mov_b32 v42, 0
  v_mov_b32 v43, 0
  buffer_store_dwordx4 v[40:43], v39, s[16:19], s64 offen offset:0 sc1
  buffer_store_dwordx4 v[40:43], v39, s[16:19], s64 offen offset:1024 sc1
  buffer_store_dwordx4 v[40:43], v39, s[16:19], s64 offen offset:2048 sc1
  buffer_store_dwordx4 v[40:43], v39, s[16:19], s64 offen offset:3072 sc1
  s_add_u32 s7, s64, 0x1000
  buffer_store_dwordx4 v[40:43], v39, s[16:19], s7 offen sc1
L_park:
  v_add_u32 v34, 49152, v32
  v_add_u32 v35, 49152, v33
  v_readfirstlane_b32 s67, v47
  s_barrier
  ds_read_b128 v[72:75], v32 offset:0
  ds_read_b128 v[76:79], v32 offset:128
  ds_read_b128 v[80:83], v32 offset:256
  ds_read_b128 v[84:87], v33 offset:0
  ds_read_b128 v[88:91], v33 offset:128
  ds_read_b128 v[92:95], v33 offset:256
  s_cmp_gt_u32 s3, 1
  s_cbranch_scc1 L_pk1
  ds_read_b128 v[96:99], v32 offset:49152
  ds_read_b128 v[100:103], v32 offset:49280
  ds_read_b128 v[104:107], v32 offset:49408
  ds_read_b128 v[108:111], v33 offset:49152
  ds_read_b128 v[112:115], v33 offset:49280
  ds_read_b128 v[116:119], v33 offset:49408
L_pk1:
  s_cmp_ge_u32 s3, 1
  s_cbranch_scc1 L_pk1b
  s_waitcnt vmcnt(0)
  s_mov_b64 exec, 1
  buffer_atomic_add v46, off, s[52:55], s68 sc1
  s_mov_b64 exec, -1
L_pk1b:
  s_cmp_gt_u32 s3, 1
  s_waitcnt lgkmcnt(0)
  s_barrier
  s_barrier
  s_cbranch_scc0 L_pk2
  ds_read_b128 v[96:99], v32 offset:49152
  ds_read_b128 v[100:103], v32 offset:49280
  ds_read_b128 v[104:107], v32 offset:49408
  ds_read_b128 v[108:111], v33 offset:49152
  ds_read_b128 v[112:115], v33 offset:49280
  ds_read_b128 v[116:119], v33 offset:49408
L_pk2:
  s_cmp_gt_u32 s3, 4
  s_cbranch_scc1 L_pk3
  ds_read_b128 v[120:123], v34 offset:49152
  ds_read_b128 v[124:127], v34 offset:49280
  ds_read_b128 v[128:131], v34 offset:49408
  ds_read_b128 v[132:135], v35 offset:49152
  ds_read_b128 v[136:139], v35 offset:49280
  ds_read_b128 v[140:143], v35 offset:49408
L_pk3:
  v_mov_b32 v38, 162368
  s_cmp_lg_u32 s3, 6
  s_waitcnt lgkmcnt(0)
  s_barrier
  s_cbranch_scc1 L_pk4
  buffer_load_dword v47, off, s[52:55], s68 sc1
L_pk4:
  s_cmp_gt_u32 s3, 4
  s_barrier
  s_cbranch_scc0 L_pk5
  ds_read_b128 v[120:123], v34 offset:49152
  ds_read_b128 v[124:127], v34 offset:49280
  ds_read_b128 v[128:131], v34 offset:49408
  ds_read_b128 v[132:135], v35 offset:49152
  ds_read_b128 v[136:139], v35 offset:49280
  ds_read_b128 v[140:143], v35 offset:49408
L_pk5:
  ds_read_b128 v[144:147], v32 offset:0
  ds_read_b128 v[148:151], v32 offset:128
  ds_read_b128 v[152:155], v32 offset:256
  ds_read_b128 v[156:159], v33 offset:0
  ds_read_b128 v[160:163], v33 offset:128
  ds_read_b128 v[164:167], v33 offset:256
  s_cmp_lg_u32 s3, 6
  s_cbranch_scc1 L_pk6
  s_movk_i32 s7, 40
  s_add_u32 s67, s67, 8
  s_mul_i32 s34, s2, 2560
  v_lshrrev_b32 v9, 4, v0
  v_lshrrev_b32 v10, 5, v0
  v_lshl_add_u32 v9, v9, 1, v10
  v_lshl_add_u32 v9, v9, 8, v39
  v_mov_b32 v52, 0
  v_mov_b32 v53, 0
  v_mov_b32 v54, 0
  v_mov_b32 v55, 0
L_pchk:
  s_waitcnt vmcnt(0)
  v_readfirstlane_b32 s69, v47
  s_cmp_lg_u32 s69, s67
  s_cbranch_scc1 L_pblk
  s_mov_b32 exec_hi, 0xffff
  buffer_load_dwordx4 v[40:43], v9, s[52:55], s34 offen offset:0 sc1
  buffer_load_dwordx4 v[44:47], v9, s[52:55], s34 offen offset:256 sc1
  buffer_load_dwordx4 v[48:51], v9, s[52:55], s34 offen offset:512 sc1
  s_mov_b32 exec_lo, 0xffff0000
  s_mov_b32 exec_hi, 0
  buffer_load_dwordx4 v[52:55], v9, s[52:55], s34 offen offset:768 sc1
  s_mov_b32 exec_lo, -1
  s_mov_b32 exec_hi, 0xffff
  v_lshlrev_b32 v8, 3, v0
  v_mov_b32 v10, 0
  v_add_u32 v8, 161792, v8
  s_waitcnt vmcnt(2)
  v_pk_add_f32 v[40:41], v[40:41], v[44:45]
  v_pk_add_f32 v[42:43], v[42:43], v[46:47]
  s_waitcnt vmcnt(0)
  v_pk_add_f32 v[48:49], v[48:49], v[52:53]
  v_pk_add_f32 v[50:51], v[50:51], v[54:55]
  v_pk_add_f32 v[40:41], v[40:41], v[48:49]
  v_pk_add_f32 v[42:43], v[42:43], v[50:51]
  v_cvt_pk_bf16_f32 v40, v40, v41
  v_cvt_pk_bf16_f32 v41, v42, v43
  ds_write_b64 v8, v[40:41]
L_pdone:
  ds_write_b32 v38, v10
  s_mov_b32 exec_hi, -1
L_pk6:
  s_waitcnt lgkmcnt(0)
  s_barrier
  ds_read_b32 v45, v38
  s_mov_b32 s69, 0
L_qjoin:
  ds_read_b128 v[48:51], v28 offset:0
  ds_read_b128 v[52:55], v28 offset:128
  ds_read_b128 v[56:59], v28 offset:256
  ds_read_b128 v[60:63], v29 offset:0
  ds_read_b128 v[64:67], v29 offset:128
  ds_read_b128 v[68:71], v29 offset:256
  s_waitcnt lgkmcnt(6)
  v_readfirstlane_b32 s7, v45
  s_cmp_lg_u32 s7, 0
  s_cbranch_scc1 L_qfb
  s_waitcnt lgkmcnt(5)
  v_mfma_f32_16x16x32_bf16 v[8:11], v[72:75], v[48:51], 0
  s_waitcnt lgkmcnt(4)
  v_mfma_f32_16x16x32_bf16 v[8:11], v[76:79], v[52:55], v[8:11]
  s_waitcnt lgkmcnt(3)
  v_mfma_f32_16x16x32_bf16 v[8:11], v[80:83], v[56:59], v[8:11]
  s_waitcnt lgkmcnt(2)
  v_mfma_f32_16x16x32_bf16 v[8:11], v[84:87], v[60:63], v[8:11]
  s_waitcnt lgkmcnt(1)
  v_mfma_f32_16x16x32_bf16 v[8:11], v[88:91], v[64:67], v[8:11]
  s_waitcnt lgkmcnt(0)
  v_mfma_f32_16x16x32_bf16 v[8:11], v[92:95], v[68:71], v[8:11]
  v_mfma_f32_16x16x32_bf16 v[14:17], v[96:99], v[48:51], 0
  v_mfma_f32_16x16x32_bf16 v[14:17], v[100:103], v[52:55], v[14:17]
  v_mfma_f32_16x16x32_bf16 v[14:17], v[104:107], v[56:59], v[14:17]
  v_mfma_f32_16x16x32_bf16 v[14:17], v[108:111], v[60:63], v[14:17]
  v_mfma_f32_16x16x32_bf16 v[14:17], v[112:115], v[64:67], v[14:17]
  v_mfma_f32_16x16x32_bf16 v[14:17], v[116:119], v[68:71], v[14:17]
  v_mfma_f32_16x16x32_bf16 v[32:35], v[120:123], v[48:51], 0
  v_mfma_f32_16x16x32_bf16 v[32:35], v[124:127], v[52:55], v[32:35]
  v_mfma_f32_16x16x32_bf16 v[32:35], v[128:131], v[56:59], v[32:35]
  v_mfma_f32_16x16x32_bf16 v[32:35], v[132:135], v[60:63], v[32:35]
  v_mfma_f32_16x16x32_bf16 v[32:35], v[136:139], v[64:67], v[32:35]
  v_mfma_f32_16x16x32_bf16 v[32:35], v[140:143], v[68:71], v[32:35]
  v_mfma_f32_16x16x32_bf16 v[40:43], v[144:147], v[48:51], 0
  v_mfma_f32_16x16x32_bf16 v[40:43], v[148:151], v[52:55], v[40:43]
  v_mfma_f32_16x16x32_bf16 v[40:43], v[152:155], v[56:59], v[40:43]
  v_mfma_f32_16x16x32_bf16 v[40:43], v[156:159], v[60:63], v[40:43]
  v_mfma_f32_16x16x32_bf16 v[40:43], v[160:163], v[64:67], v[40:43]
  v_mfma_f32_16x16x32_bf16 v[40:43], v[164:167], v[68:71], v[40:43]
  s_add_u32 s56, s56, 49152
  s_mul_i32 s57, s3, 6
  s_add_u32 s57, s57, 198
  s_movk_i32 s58, 256
  v_cndmask_b32 v8, v8, v9, s[24:25]
  v_cndmask_b32 v8, v8, v10, s[26:27]
  v_cndmask_b32 v8, v8, v11, s[28:29]
  v_cvt_pk_bf16_f32 v8, v8, v8
  v_lshlrev_b32 v8, 16, v8
  v_mul_f32 v8, s65, v8
  v_cvt_pk_bf16_f32 v12, v8, v8
  s_mov_b64 exec, s[30:31]
  ds_write_b16 v31, v12
  s_mov_b64 exec, -1
  v_add_u32 v31, 32, v31
  v_cndmask_b32 v14, v14, v15, s[24:25]
  v_cndmask_b32 v14, v14, v16, s[26:27]
  v_cndmask_b32 v14, v14, v17, s[28:29]
  v_cvt_pk_bf16_f32 v14, v14, v14
  v_lshlrev_b32 v14, 16, v14
  v_mul_f32 v14, s65, v14
  v_cvt_pk_bf16_f32 v18, v14, v14
  s_mov_b64 exec, s[30:31]
  ds_write_b16 v31, v18
  s_mov_b64 exec, -1
  v_add_u32 v31, 32, v31
  v_cndmask_b32 v32, v32, v33, s[24:25]
  v_cndmask_b32 v32, v32, v34, s[26:27]
  v_cndmask_b32 v32, v32, v35, s[28:29]
  v_cvt_pk_bf16_f32 v32, v32, v32
  v_lshlrev_b32 v32, 16, v32
  v_mul_f32 v32, s65, v32
  v_cvt_pk_bf16_f32 v36, v32, v32
  s_mov_b64 exec, s[30:31]
  ds_write_b16 v31, v36
  s_mov_b64 exec, -1
  v_add_u32 v31, 32, v31
  v_cndmask_b32 v40, v40, v41, s[24:25]
  v_cndmask_b32 v40, v40, v42, s[26:27]
  v_cndmask_b32 v40, v40, v43, s[28:29]
  v_cvt_pk_bf16_f32 v40, v40, v40
  v_lshlrev_b32 v40, 16, v40
  v_mul_f32 v40, s65, v40
  v_cvt_pk_bf16_f32 v44, v40, v40
  s_mov_b64 exec, s[30:31]
  ds_write_b16 v31, v44
  s_mov_b64 exec, -1
  v_add_u32 v31, 32, v31
  s_cmp_lg_u32 s69, 0
  s_cbranch_scc1 L_k
  s_barrier
L_k:
  s_cmp_gt_u32 s57, s58
  s_cbranch_scc1 L_kn
  v_add_u32 v32, s56, v26
  v_add_u32 v33, s56, v27
  ds_read_b128 v[72:75], v32 offset:0
  ds_read_b128 v[76:79], v32 offset:128
  ds_read_b128 v[80:83], v32 offset:256
  ds_read_b128 v[84:87], v33 offset:0
  ds_read_b128 v[88:91], v33 offset:128
  ds_read_b128 v[92:95], v33 offset:256
  s_add_u32 s56, s56, 49152
  s_sub_u32 s59, s56, 147456
  s_cselect_b32 s56, s56, s59
  s_add_u32 s57, s57, 48
  s_waitcnt lgkmcnt(5)
  v_mfma_f32_16x16x32_bf16 v[96:99], v[72:75], v[48:51], 0
  s_waitcnt lgkmcnt(4)
  v_mfma_f32_16x16x32_bf16 v[96:99], v[76:79], v[52:55], v[96:99]
  s_waitcnt lgkmcnt(3)
  v_mfma_f32_16x16x32_bf16 v[96:99], v[80:83], v[56:59], v[96:99]
  s_waitcnt lgkmcnt(2)
  v_mfma_f32_16x16x32_bf16 v[96:99], v[84:87], v[60:63], v[96:99]
  s_waitcnt lgkmcnt(1)
  v_mfma_f32_16x16x32_bf16 v[96:99], v[88:91], v[64:67], v[96:99]
  s_waitcnt lgkmcnt(0)
  v_mfma_f32_16x16x32_bf16 v[96:99], v[92:95], v[68:71], v[96:99]
  s_nop 7
  v_cndmask_b32 v96, v96, v97, s[24:25]
  v_cndmask_b32 v96, v96, v98, s[26:27]
  v_cndmask_b32 v96, v96, v99, s[28:29]
  v_cvt_pk_bf16_f32 v96, v96, v96
  v_lshlrev_b32 v96, 16, v96
  v_mul_f32 v96, s65, v96
  v_cvt_pk_bf16_f32 v100, v96, v96
  s_mov_b64 exec, s[30:31]
  ds_write_b16 v31, v100
  s_mov_b64 exec, -1
  v_add_u32 v31, 32, v31
  s_branch L_k
L_kn:
  s_add_u32 s58, s58, 64
  s_cmp_gt_u32 s58, 1536
  s_cbranch_scc1 L_sm
  s_barrier
  s_barrier
  s_branch L_k
L_sm:
  v_add_u32 v38, s62, v39
  s_waitcnt lgkmcnt(0)
  ds_read_b128 v[72:75], v38
  s_cmp_lg_u32 s61, 0
  s_cbranch_scc1 L_nodone
  s_waitcnt vmcnt(0)
  s_mov_b64 exec, 1
  v_mov_b32 v46, 0x10000
  buffer_atomic_add v46, off, s[20:23], s63
  s_mov_b64 exec, -1
L_nodone:
  s_lshl_b32 s7, s3, 2
  s_add_u32 s7, s7, 162304
  v_mov_b32 v32, s7
  v_mov_b32 v33, 162304
  s_waitcnt lgkmcnt(0)
  v_lshlrev_b32 v76, 16, v72
  v_and_b32 v77, 0xffff0000, v72
  v_lshlrev_b32 v78, 16, v73
  v_and_b32 v79, 0xffff0000, v73
  v_lshlrev_b32 v80, 16, v74
  v_and_b32 v81, 0xffff0000, v74
  v_lshlrev_b32 v82, 16, v75
  v_and_b32 v83, 0xffff0000, v75
  v_max3_f32 v84, v76, v77, v78
  v_max3_f32 v85, v79, v80, v81
  v_max3_f32 v84, v84, v82, v83
  v_max_f32 v84, v84, v85
  s_nop 1
  v_max_f32_dpp v84, v84, v84 row_shr:1 row_mask:0xf bank_mask:0xf
  s_nop 1
  v_max_f32_dpp v84, v84, v84 row_shr:2 row_mask:0xf bank_mask:0xf
  s_nop 1
  v_max_f32_dpp v84, v84, v84 row_shr:4 row_mask:0xf bank_mask:0xf
  s_nop 1
  v_max_f32_dpp v84, v84, v84 row_shr:8 row_mask:0xf bank_mask:0xf
  s_nop 1
  v_max_f32_dpp v84, v84, v84 row_bcast:15 row_mask:0xa bank_mask:0xf
  s_nop 1
  v_max_f32_dpp v84, v84, v84 row_bcast:31 row_mask:0xc bank_mask:0xf
  s_mov_b32 exec_lo, 0
  s_brev_b32 exec_hi, 1
  ds_write_b32 v32, v84
  s_mov_b64 exec, -1
  s_waitcnt lgkmcnt(0)
  s_barrier
  ds_read_b128 v[88:91], v33
  ds_read_b128 v[92:95], v33 offset:16
  s_mov_b32 s7, 0x3fb8aa3b
  s_waitcnt lgkmcnt(0)
  v_max3_f32 v84, v88, v89, v90
  v_max3_f32 v85, v91, v92, v93
  v_max3_f32 v84, v84, v94, v95
  v_max_f32 v84, v84, v85
  v_sub_f32 v76, v76, v84
  v_sub_f32 v77, v77, v84
  v_sub_f32 v78, v78, v84
  v_sub_f32 v79, v79, v84
  v_sub_f32 v80, v80, v84
  v_sub_f32 v81, v81, v84
  v_sub_f32 v82, v82, v84
  v_sub_f32 v83, v83, v84
  v_mul_f32 v76, s7, v76
  v_mul_f32 v77, s7, v77
  v_mul_f32 v78, s7, v78
  v_mul_f32 v79, s7, v79
  v_mul_f32 v80, s7, v80
  v_mul_f32 v81, s7, v81
  v_mul_f32 v82, s7, v82
  v_mul_f32 v83, s7, v83
  v_exp_f32 v76, v76
  v_exp_f32 v77, v77
  v_exp_f32 v78, v78
  v_exp_f32 v79, v79
  v_exp_f32 v80, v80
  v_exp_f32 v81, v81
  v_exp_f32 v82, v82
  v_exp_f32 v83, v83
  s_nop 0
  v_add_f32 v84, v76, v77
  v_add_f32 v85, v78, v79
  v_add_f32 v86, v80, v81
  v_add_f32 v87, v82, v83
  v_add_f32 v84, v84, v85
  v_add_f32 v86, v86, v87
  v_add_f32 v84, v84, v86
  s_nop 1
  v_add_f32_dpp v84, v84, v84 row_shr:1 row_mask:0xf bank_mask:0xf
  s_nop 1
  v_add_f32_dpp v84, v84, v84 row_shr:2 row_mask:0xf bank_mask:0xf
  s_nop 1
  v_add_f32_dpp v84, v84, v84 row_shr:4 row_mask:0xf bank_mask:0xf
  s_nop 1
  v_add_f32_dpp v84, v84, v84 row_shr:8 row_mask:0xf bank_mask:0xf
  s_nop 1
  v_add_f32_dpp v84, v84, v84 row_bcast:15 row_mask:0xa bank_mask:0xf
  s_nop 1
  v_add_f32_dpp v84, v84, v84 row_bcast:31 row_mask:0xc bank_mask:0xf
  s_mov_b32 exec_lo, 0
  s_brev_b32 exec_hi, 1
  ds_write_b32 v32, v84 offset:32
  s_mov_b64 exec, -1
  v_mul_u32_u24 v0, 384, v1
  v_lshl_add_u32 v0, v2, 4, v0
  v_lshlrev_b32 v1, 2, v1
  v_add_u32 v1, s62, v1
  v_mov_b32 v12, 0
  v_mov_b32 v13, 0
  v_mov_b32 v14, 0
  v_mov_b32 v15, 0
  v_mov_b32 v16, 0
  v_mov_b32 v17, 0
  v_mov_b32 v18, 0
  v_mov_b32 v19, 0
  v_mov_b32 v20, 0
  v_mov_b32 v21, 0
  v_mov_b32 v22, 0
  v_mov_b32 v23, 0
  s_mov_b32 s8, s44
  s_mov_b32 s9, s45
  s_mul_i32 s34, s5, 245760
  s_mul_i32 s7, s3, 30720
  s_add_u32 s34, s34, s7
  s_getpc_b64 s[92:93]
L_pc:
  s_add_u32 s92, s92, L_wo-L_pc
  s_addc_u32 s93, s93, 0
  s_add_u32 s87, s34, 15360
  s_add_u32 s88, s34, 2560
  s_add_u32 s89, s34, 17920
  s_add_u32 s90, s34, 5120
  s_add_u32 s91, s34, 20480
  s_mul_i32 s7, s4, 15
  s_lshr_b32 s7, s7, 2
  s_mul_i32 s7, s7, 12
  s_add_u32 s92, s92, s7
  s_addc_u32 s93, s93, 0
  s_waitcnt lgkmcnt(0)
  s_barrier
  ds_read_b128 v[88:91], v33 offset:32
  ds_read_b128 v[92:95], v33 offset:48
  s_waitcnt lgkmcnt(0)
  v_add_f32 v84, v88, v89
  v_add_f32 v85, v90, v91
  v_add_f32 v86, v92, v93
  v_add_f32 v87, v94, v95
  v_add_f32 v84, v84, v85
  v_add_f32 v86, v86, v87
  v_add_f32 v84, v84, v86
  v_rcp_f32 v84, v84
  s_nop 0
  v_mul_f32 v76, v84, v76
  v_mul_f32 v77, v84, v77
  v_mul_f32 v78, v84, v78
  v_mul_f32 v79, v84, v79
  v_mul_f32 v80, v84, v80
  v_mul_f32 v81, v84, v81
  v_mul_f32 v82, v84, v82
  v_mul_f32 v83, v84, v83
  v_cvt_pk_bf16_f32 v72, v76, v77
  v_cvt_pk_bf16_f32 v73, v78, v79
  v_cvt_pk_bf16_f32 v74, v80, v81
  v_cvt_pk_bf16_f32 v75, v82, v83
  ds_write_b128 v38, v[72:75]
  s_waitcnt lgkmcnt(0)
L_v:
  s_cmp_gt_u32 s57, s58
  s_cbranch_scc1 L_vn
  v_add_u32 v2, s56, v0
  ds_read_b32 v3, v1
  ds_read_b128 v[24:27], v2 offset:0
  ds_read_b128 v[28:31], v2 offset:128
  ds_read_b128 v[32:35], v2 offset:256
  ds_read_b128 v[36:39], v2 offset:3072
  ds_read_b128 v[40:43], v2 offset:3200
  ds_read_b128 v[44:47], v2 offset:3328
  v_add_u32 v1, 32, v1
  s_add_u32 s56, s56, 49152
  s_sub_u32 s59, s56, 147456
  s_cselect_b32 s56, s56, s59
  s_add_u32 s57, s57, 48
  s_waitcnt lgkmcnt(6)
  v_mul_u32_u24_sdwa v8, v3, v4 dst_sel:DWORD dst_unused:UNUSED_PAD src0_sel:WORD_0 src1_sel:DWORD
  v_mul_u32_u24_sdwa v9, v3, v5 dst_sel:DWORD dst_unused:UNUSED_PAD src0_sel:WORD_0 src1_sel:DWORD
  v_mul_u32_u24_sdwa v10, v3, v6 dst_sel:DWORD dst_unused:UNUSED_PAD src0_sel:WORD_0 src1_sel:DWORD
  v_mul_u32_u24_sdwa v11, v3, v7 dst_sel:DWORD dst_unused:UNUSED_PAD src0_sel:WORD_0 src1_sel:DWORD
  s_nop 0
  s_waitcnt lgkmcnt(5)
  v_mfma_f32_16x16x32_bf16 v[12:15], v[8:11], v[24:27], v[12:15]
  s_waitcnt lgkmcnt(4)
  v_mfma_f32_16x16x32_bf16 v[16:19], v[8:11], v[28:31], v[16:19]
  s_waitcnt lgkmcnt(3)
  v_mfma_f32_16x16x32_bf16 v[20:23], v[8:11], v[32:35], v[20:23]
  v_mul_u32_u24_sdwa v8, v3, v4 dst_sel:DWORD dst_unused:UNUSED_PAD src0_sel:WORD_1 src1_sel:DWORD
  v_mul_u32_u24_sdwa v9, v3, v5 dst_sel:DWORD dst_unused:UNUSED_PAD src0_sel:WORD_1 src1_sel:DWORD
  v_mul_u32_u24_sdwa v10, v3, v6 dst_sel:DWORD dst_unused:UNUSED_PAD src0_sel:WORD_1 src1_sel:DWORD
  v_mul_u32_u24_sdwa v11, v3, v7 dst_sel:DWORD dst_unused:UNUSED_PAD src0_sel:WORD_1 src1_sel:DWORD
  s_nop 0
  s_waitcnt lgkmcnt(2)
  v_mfma_f32_16x16x32_bf16 v[12:15], v[8:11], v[36:39], v[12:15]
  s_waitcnt lgkmcnt(1)
  v_mfma_f32_16x16x32_bf16 v[16:19], v[8:11], v[40:43], v[16:19]
  s_waitcnt lgkmcnt(0)
  v_mfma_f32_16x16x32_bf16 v[20:23], v[8:11], v[44:47], v[20:23]
  s_branch L_v
L_vn:
  s_add_u32 s58, s58, 64
  s_cmp_gt_u32 s58, 3072
  s_cbranch_scc1 L_tail
  s_cmp_le_u32 s58, 2560
  s_cbranch_scc1 L_vw
  s_barrier
  s_cmp_eq_u32 s58, 3072
  s_cmovk_i32 s58, 3024
  s_cbranch_scc1 L_v
  s_barrier
  s_branch L_v
L_vw:
  v_mbcnt_lo_u32_b32 v2, -1, 0
  v_mbcnt_hi_u32_b32 v2, -1, v2
  v_lshrrev_b32 v3, 5, v2
  v_bfe_u32 v24, v2, 4, 1
  v_mul_u32_u24 v3, 7680, v3
  v_mul_u32_u24 v24, 1280, v24
  v_and_b32 v2, 15, v2
  v_lshlrev_b32 v2, 4, v2
  v_add3_u32 v2, v2, v3, v24
  s_swappc_b64 s[94:95], s[92:93]
  s_barrier
  s_swappc_b64 s[94:95], s[92:93]
  s_barrier
  s_branch L_v
L_wo:
  buffer_load_dwordx4 v[48:51], v2, s[8:11], s34 offen offset:0
  s_swappc_b64 s[92:93], s[94:95]
  buffer_load_dwordx4 v[56:59], v2, s[8:11], s34 offen offset:256
  s_swappc_b64 s[92:93], s[94:95]
  buffer_load_dwordx4 v[64:67], v2, s[8:11], s34 offen offset:512
  s_swappc_b64 s[92:93], s[94:95]
  buffer_load_dwordx4 v[72:75], v2, s[8:11], s34 offen offset:768
  s_swappc_b64 s[92:93], s[94:95]
  buffer_load_dwordx4 v[80:83], v2, s[8:11], s34 offen offset:1024
  s_swappc_b64 s[92:93], s[94:95]
  buffer_load_dwordx4 v[52:55], v2, s[8:11], s87 offen offset:0
  s_swappc_b64 s[92:93], s[94:95]
  buffer_load_dwordx4 v[60:63], v2, s[8:11], s87 offen offset:256
  s_swappc_b64 s[92:93], s[94:95]
  buffer_load_dwordx4 v[68:71], v2, s[8:11], s87 offen offset:512
  s_swappc_b64 s[92:93], s[94:95]
  buffer_load_dwordx4 v[76:79], v2, s[8:11], s87 offen offset:768
  s_swappc_b64 s[92:93], s[94:95]
  buffer_load_dwordx4 v[84:87], v2, s[8:11], s87 offen offset:1024
  s_swappc_b64 s[92:93], s[94:95]
  buffer_load_dwordx4 v[88:91], v2, s[8:11], s88 offen offset:0
  s_swappc_b64 s[92:93], s[94:95]
  buffer_load_dwordx4 v[96:99], v2, s[8:11], s88 offen offset:256
  s_swappc_b64 s[92:93], s[94:95]
  buffer_load_dwordx4 v[104:107], v2, s[8:11], s88 offen offset:512
  s_swappc_b64 s[92:93], s[94:95]
  buffer_load_dwordx4 v[112:115], v2, s[8:11], s88 offen offset:768
  s_swappc_b64 s[92:93], s[94:95]
  buffer_load_dwordx4 v[120:123], v2, s[8:11], s88 offen offset:1024
  s_swappc_b64 s[92:93], s[94:95]
  buffer_load_dwordx4 v[92:95], v2, s[8:11], s89 offen offset:0
  s_swappc_b64 s[92:93], s[94:95]
  buffer_load_dwordx4 v[100:103], v2, s[8:11], s89 offen offset:256
  s_swappc_b64 s[92:93], s[94:95]
  buffer_load_dwordx4 v[108:111], v2, s[8:11], s89 offen offset:512
  s_swappc_b64 s[92:93], s[94:95]
  buffer_load_dwordx4 v[116:119], v2, s[8:11], s89 offen offset:768
  s_swappc_b64 s[92:93], s[94:95]
  buffer_load_dwordx4 v[124:127], v2, s[8:11], s89 offen offset:1024
  s_swappc_b64 s[92:93], s[94:95]
  buffer_load_dwordx4 v[128:131], v2, s[8:11], s90 offen offset:0
  s_swappc_b64 s[92:93], s[94:95]
  buffer_load_dwordx4 v[136:139], v2, s[8:11], s90 offen offset:256
  s_swappc_b64 s[92:93], s[94:95]
  buffer_load_dwordx4 v[144:147], v2, s[8:11], s90 offen offset:512
  s_swappc_b64 s[92:93], s[94:95]
  buffer_load_dwordx4 v[152:155], v2, s[8:11], s90 offen offset:768
  s_swappc_b64 s[92:93], s[94:95]
  buffer_load_dwordx4 v[160:163], v2, s[8:11], s90 offen offset:1024
  s_swappc_b64 s[92:93], s[94:95]
  buffer_load_dwordx4 v[132:135], v2, s[8:11], s91 offen offset:0
  s_swappc_b64 s[92:93], s[94:95]
  buffer_load_dwordx4 v[140:143], v2, s[8:11], s91 offen offset:256
  s_swappc_b64 s[92:93], s[94:95]
  buffer_load_dwordx4 v[148:151], v2, s[8:11], s91 offen offset:512
  s_swappc_b64 s[92:93], s[94:95]
  buffer_load_dwordx4 v[156:159], v2, s[8:11], s91 offen offset:768
  s_swappc_b64 s[92:93], s[94:95]
  buffer_load_dwordx4 v[164:167], v2, s[8:11], s91 offen offset:1024
  s_swappc_b64 s[92:93], s[94:95]
  s_branch L_wo
L_tail:
  v_add_u32 v2, s56, v0
  ds_read_b32 v3, v1
  v_mbcnt_lo_u32_b32 v36, -1, 0
  v_mbcnt_hi_u32_b32 v36, -1, v36
  v_lshrrev_b32 v37, 5, v36
  v_mul_u32_u24 v37, 784, v37
  v_and_b32 v38, 7, v36
  v_lshl_add_u32 v37, v38, 5, v37
  v_and_b32 v38, 16, v36
  s_mul_i32 s7, s3, 1568
  s_add_u32 s7, s7, 49152
  v_add3_u32 v0, v37, v38, s7
  v_and_b32 v37, 15, v36
  v_mul_u32_u24 v37, 784, v37
  v_lshrrev_b32 v38, 4, v36
  v_mul_u32_u24 v38, 24, v38
  s_mul_i32 s7, s3, 96
  s_add_u32 s7, s7, 49152
  s_waitcnt lgkmcnt(0)
  v_add3_u32 v1, v37, v38, s7
  v_mul_u32_u24_sdwa v8, v3, v4 dst_sel:DWORD dst_unused:UNUSED_PAD src0_sel:WORD_0 src1_sel:DWORD
  v_mul_u32_u24_sdwa v9, v3, v5 dst_sel:DWORD dst_unused:UNUSED_PAD src0_sel:WORD_0 src1_sel:DWORD
  v_mul_u32_u24_sdwa v10, v3, v6 dst_sel:DWORD dst_unused:UNUSED_PAD src0_sel:WORD_0 src1_sel:DWORD
  v_mul_u32_u24_sdwa v11, v3, v7 dst_sel:DWORD dst_unused:UNUSED_PAD src0_sel:WORD_0 src1_sel:DWORD
  v_mul_u32_u24_sdwa v44, v3, v4 dst_sel:DWORD dst_unused:UNUSED_PAD src0_sel:WORD_1 src1_sel:DWORD
  v_mul_u32_u24_sdwa v45, v3, v5 dst_sel:DWORD dst_unused:UNUSED_PAD src0_sel:WORD_1 src1_sel:DWORD
  v_mul_u32_u24_sdwa v46, v3, v6 dst_sel:DWORD dst_unused:UNUSED_PAD src0_sel:WORD_1 src1_sel:DWORD
  v_mul_u32_u24_sdwa v47, v3, v7 dst_sel:DWORD dst_unused:UNUSED_PAD src0_sel:WORD_1 src1_sel:DWORD
  v_bfe_i32 v5, v36, 2, 1
  v_and_b32 v5, 0xffff, v5
  v_xor_b32 v4, 0xffff, v5
  v_lshlrev_b32 v6, 16, v4
  v_lshlrev_b32 v7, 16, v5
  v_and_b32 v3, 3, v36
  v_mul_u32_u24 v3, 0x5555, v3
  v_mov_b32 v36, 0
  v_mov_b32 v37, 0
  v_mov_b32 v38, 0
  v_mov_b32 v39, 0
  v_mov_b32 v40, 0
  v_mov_b32 v41, 0
  v_mov_b32 v42, 0
  v_mov_b32 v43, 0
  s_mul_i32 s7, s3, 2576
  s_add_u32 s7, s7, 65536
  s_mov_b32 s12, s46
  s_mov_b32 s13, s47
  s_mul_i32 s35, s4, 1280
  s_mov_b32 s66, 0
  s_mov_b32 s67, 0x42700000
  s_lshl_b32 s34, s3, 6
  s_waitcnt vmcnt(0)
  s_barrier
  ds_read_b128 v[24:27], v2 offset:0
  ds_read_b128 v[28:31], v2 offset:128
  ds_read_b128 v[32:35], v2 offset:256
  s_waitcnt lgkmcnt(2)
  v_mfma_f32_16x16x32_bf16 v[12:15], v[8:11], v[24:27], v[12:15]
  s_waitcnt lgkmcnt(1)
  v_mfma_f32_16x16x32_bf16 v[16:19], v[8:11], v[28:31], v[16:19]
  s_waitcnt lgkmcnt(0)
  v_mfma_f32_16x16x32_bf16 v[20:23], v[8:11], v[32:35], v[20:23]
  s_barrier
  ds_read_b128 v[24:27], v2 offset:3072
  ds_read_b128 v[28:31], v2 offset:3200
  ds_read_b128 v[32:35], v2 offset:3328
  v_mbcnt_lo_u32_b32 v2, -1, 0
  v_mbcnt_hi_u32_b32 v2, -1, v2
  s_waitcnt lgkmcnt(2)
  v_mfma_f32_16x16x32_bf16 v[12:15], v[44:47], v[24:27], v[12:15]
  s_waitcnt lgkmcnt(1)
  v_mfma_f32_16x16x32_bf16 v[16:19], v[44:47], v[28:31], v[16:19]
  s_waitcnt lgkmcnt(0)
  v_mfma_f32_16x16x32_bf16 v[20:23], v[44:47], v[32:35], v[20:23]
  v_mov_b32 v24, 0
  v_mov_b32 v25, 0
  v_mov_b32 v26, 0
  v_mov_b32 v27, 0
  v_mov_b32 v28, 0
  v_mov_b32 v29, 0
  s_mov_b64 exec, s[32:33]
  ds_write_b128 v0, v[12:15] offset:0
  ds_write_b128 v0, v[16:19] offset:256
  ds_write_b128 v0, v[20:23] offset:512
  s_mov_b64 exec, -1
  v_mov_b32 v30, 0
  v_mov_b32 v31, 0
  v_mov_b32 v32, 0
  v_mov_b32 v33, 0
  v_mov_b32 v34, 0
  v_mov_b32 v35, 0
  v_and_b32 v44, 15, v2
  v_lshlrev_b32 v44, 5, v44
  v_and_b32 v45, 16, v2
  v_add3_u32 v0, v44, v45, s7
  v_add_u32 v2, s34, v2
  s_waitcnt lgkmcnt(0)
  s_barrier
  ds_read_b64 v[12:13], v1 offset:0
  ds_read_b64 v[14:15], v1 offset:8
  ds_read_b64 v[16:17], v1 offset:16
  v_lshlrev_b32 v21, 2, v2
  v_lshlrev_b32 v2, 3, v2
  v_add_u32 v1, 65536, v2
  s_waitcnt lgkmcnt(2)
  v_add_f32_dpp v12, v12, v12 quad_perm:[1,0,3,2] row_mask:0xf bank_mask:0xf
  v_add_f32_dpp v13, v13, v13 quad_perm:[1,0,3,2] row_mask:0xf bank_mask:0xf
  s_waitcnt lgkmcnt(1)
  v_add_f32_dpp v14, v14, v14 quad_perm:[1,0,3,2] row_mask:0xf bank_mask:0xf
  v_add_f32_dpp v15, v15, v15 quad_perm:[1,0,3,2] row_mask:0xf bank_mask:0xf
  s_waitcnt lgkmcnt(0)
  v_add_f32_dpp v16, v16, v16 quad_perm:[1,0,3,2] row_mask:0xf bank_mask:0xf
  v_add_f32_dpp v17, v17, v17 quad_perm:[1,0,3,2] row_mask:0xf bank_mask:0xf
  v_add_f32_dpp v12, v12, v12 quad_perm:[2,3,0,1] row_mask:0xf bank_mask:0xf
  v_add_f32_dpp v13, v13, v13 quad_perm:[2,3,0,1] row_mask:0xf bank_mask:0xf
  v_add_f32_dpp v14, v14, v14 quad_perm:[2,3,0,1] row_mask:0xf bank_mask:0xf
  v_add_f32_dpp v15, v15, v15 quad_perm:[2,3,0,1] row_mask:0xf bank_mask:0xf
  v_add_f32_dpp v16, v16, v16 quad_perm:[2,3,0,1] row_mask:0xf bank_mask:0xf
  v_add_f32_dpp v17, v17, v17 quad_perm:[2,3,0,1] row_mask:0xf bank_mask:0xf
  v_add_f32_dpp v12, v12, v12 row_half_mirror row_mask:0xf bank_mask:0xf
  v_add_f32_dpp v13, v13, v13 row_half_mirror row_mask:0xf bank_mask:0xf
  v_add_f32_dpp v14, v14, v14 row_half_mirror row_mask:0xf bank_mask:0xf
  v_add_f32_dpp v15, v15, v15 row_half_mirror row_mask:0xf bank_mask:0xf
  v_add_f32_dpp v16, v16, v16 row_half_mirror row_mask:0xf bank_mask:0xf
  v_add_f32_dpp v17, v17, v17 row_half_mirror row_mask:0xf bank_mask:0xf
  v_add_f32_dpp v12, v12, v12 row_mirror row_mask:0xf bank_mask:0xf
  v_add_f32_dpp v13, v13, v13 row_mirror row_mask:0xf bank_mask:0xf
  v_add_f32_dpp v14, v14, v14 row_mirror row_mask:0xf bank_mask:0xf
  v_add_f32_dpp v15, v15, v15 row_mirror row_mask:0xf bank_mask:0xf
  v_add_f32_dpp v16, v16, v16 row_mirror row_mask:0xf bank_mask:0xf
  v_add_f32_dpp v17, v17, v17 row_mirror row_mask:0xf bank_mask:0xf
  v_cvt_pk_bf16_f32 v18, v12, v13
  v_cvt_pk_bf16_f32 v19, v14, v15
  v_cvt_pk_bf16_f32 v20, v16, v17
  v_and_b32 v8, v18, v4
  v_and_b32 v9, v18, v5
  v_and_b32 v10, v18, v6
  v_and_b32 v11, v18, v7
  v_and_b32 v44, v19, v4
  v_and_b32 v45, v19, v5
  v_and_b32 v46, v19, v6
  v_and_b32 v47, v19, v7
  v_smfmac_f32_16x16x64_bf16 v[24:27], v[8:11], v[48:55], v3
  v_smfmac_f32_16x16x64_bf16 v[28:31], v[8:11], v[56:63], v3
  v_and_b32 v12, v20, v4
  v_and_b32 v13, v20, v5
  v_and_b32 v14, v20, v6
  v_and_b32 v15, v20, v7
  v_smfmac_f32_16x16x64_bf16 v[32:35], v[8:11], v[64:71], v3
  v_smfmac_f32_16x16x64_bf16 v[36:39], v[8:11], v[72:79], v3
  v_smfmac_f32_16x16x64_bf16 v[40:43], v[8:11], v[80:87], v3
  v_smfmac_f32_16x16x64_bf16 v[24:27], v[44:47], v[88:95], v3
  v_smfmac_f32_16x16x64_bf16 v[28:31], v[44:47], v[96:103], v3
  v_smfmac_f32_16x16x64_bf16 v[32:35], v[44:47], v[104:111], v3
  v_smfmac_f32_16x16x64_bf16 v[36:39], v[44:47], v[112:119], v3
  v_smfmac_f32_16x16x64_bf16 v[40:43], v[44:47], v[120:127], v3
  v_smfmac_f32_16x16x64_bf16 v[24:27], v[12:15], v[128:135], v3
  v_smfmac_f32_16x16x64_bf16 v[28:31], v[12:15], v[136:143], v3
  v_smfmac_f32_16x16x64_bf16 v[32:35], v[12:15], v[144:151], v3
  v_smfmac_f32_16x16x64_bf16 v[36:39], v[12:15], v[152:159], v3
  v_smfmac_f32_16x16x64_bf16 v[40:43], v[12:15], v[160:167], v3
  s_mov_b32 exec_hi, 0
  s_nop 7
  ds_write_b128 v0, v[24:27] offset:0
  ds_write_b128 v0, v[28:31] offset:512
  ds_write_b128 v0, v[32:35] offset:1024
  ds_write_b128 v0, v[36:39] offset:1536
  ds_write_b128 v0, v[40:43] offset:2048
  s_mov_b32 exec_hi, -1
  v_mov_b32 v44, 0
  v_mov_b32 v45, 0x43380000
  v_mov_b32 v46, v21
  s_cmp_ge_u32 s3, 5
  s_waitcnt lgkmcnt(0)
  s_barrier
  s_cbranch_scc1 L_fin
  ds_read_b64 v[12:13], v1 offset:0
  ds_read_b64 v[14:15], v1 offset:2576
  ds_read_b64 v[16:17], v1 offset:5152
  ds_read_b64 v[18:19], v1 offset:7728
  ds_read_b64 v[20:21], v1 offset:10304
  ds_read_b64 v[22:23], v1 offset:12880
  ds_read_b64 v[24:25], v1 offset:15456
  ds_read_b64 v[26:27], v1 offset:18032
  s_waitcnt lgkmcnt(6)
  v_pk_add_f32 v[12:13], v[12:13], v[14:15]
  s_waitcnt lgkmcnt(4)
  v_pk_add_f32 v[16:17], v[16:17], v[18:19]
  s_waitcnt lgkmcnt(2)
  v_pk_add_f32 v[20:21], v[20:21], v[22:23]
  s_waitcnt lgkmcnt(0)
  v_pk_add_f32 v[24:25], v[24:25], v[26:27]
  v_pk_add_f32 v[12:13], v[12:13], v[16:17]
  v_pk_add_f32 v[20:21], v[20:21], v[24:25]
  v_pk_add_f32 v[12:13], v[12:13], v[20:21]
  v_cvt_f64_f32 v[16:17], v12
  v_cvt_f64_f32 v[18:19], v13
  v_fma_f64 v[16:17], v[16:17], s[66:67], v[44:45]
  v_fma_f64 v[18:19], v[18:19], s[66:67], v[44:45]
  v_mov_b32 v20, v16
  v_mov_b32 v21, v17
  v_mov_b32 v22, v18
  v_mov_b32 v23, v19
  buffer_atomic_add_x2 v[20:21], v2, s[16:19], s64 offen sc0
  buffer_atomic_add_x2 v[22:23], v2, s[16:19], s64 offen offset:2560 sc0
  v_subrev_u32 v17, 600309760, v17
  v_subrev_u32 v19, 600309760, v19
  s_mov_b32 s67, 0x3d700000
  s_waitcnt vmcnt(1)
  v_add_co_u32 v16, vcc, v16, v20
  s_nop 1
  v_addc_co_u32 v17, vcc, v17, v21, vcc
  v_lshrrev_b32 v24, 20, v17
  v_add_f64 v[16:17], v[16:17], -v[44:45]
  v_cmp_eq_u32 vcc, 0x433, v24
  v_mul_f64 v[16:17], v[16:17], s[66:67]
  v_cvt_f32_f64 v16, v[16:17]
  v_cvt_pk_bf16_f32 v16, v16, v16
  s_and_saveexec_b64 s[68:69], vcc
  s_cbranch_execz L_ns0
  buffer_store_short v16, v46, s[12:15], s35 offen offset:0
L_ns0:
  s_mov_b64 exec, s[68:69]
  s_waitcnt vmcnt(0)
  v_add_co_u32 v18, vcc, v18, v22
  s_nop 1
  v_addc_co_u32 v19, vcc, v19, v23, vcc
  v_lshrrev_b32 v24, 20, v19
  v_add_f64 v[18:19], v[18:19], -v[44:45]
  v_cmp_eq_u32 vcc, 0x433, v24
  v_mul_f64 v[18:19], v[18:19], s[66:67]
  v_cvt_f32_f64 v18, v[18:19]
  v_cvt_pk_bf16_f32 v18, v18, v18
  s_and_saveexec_b64 s[68:69], vcc
  s_cbranch_execz L_ns1
  buffer_store_short v18, v46, s[12:15], s35 offen offset:2
L_ns1:
  s_mov_b64 exec, s[68:69]
L_fin:
L_end:
  s_endpgm
L_pblk:
  buffer_load_dword v47, off, s[52:55], s68 sc1
  s_sub_u32 s7, s7, 1
  s_cbranch_scc0 L_pchk
  s_waitcnt vmcnt(0)
  v_mov_b32 v10, 1
  s_branch L_pdone
L_slow:
  s_mov_b64 exec, 1
  v_mov_b32 v8, 1
  buffer_atomic_add v8, off, s[20:23], s7 sc0
  s_waitcnt vmcnt(0)
  v_readfirstlane_b32 s5, v8
  s_cmp_lg_u32 s5, 0
  s_cbranch_scc1 L_spin2
  s_mov_b64 exec, -1
  s_add_u32 s16, s50, 1048576
  s_addc_u32 s17, s51, 0
  s_mov_b32 s18, 40960
  s_mov_b32 s19, 0x20000
  s_mul_i32 s34, s4, 5120
  v_mov_b32 v12, 0
  v_mov_b32 v13, 0
  v_mov_b32 v14, 0
  v_mov_b32 v15, 0
  buffer_store_dwordx4 v[12:15], v2, s[16:19], s34 offen offset:0 sc1
  buffer_store_dwordx4 v[12:15], v2, s[16:19], s34 offen offset:1024 sc1
  buffer_store_dwordx4 v[12:15], v2, s[16:19], s34 offen offset:2048 sc1
  buffer_store_dwordx4 v[12:15], v2, s[16:19], s34 offen offset:3072 sc1
  s_addk_i32 s34, 0x1000
  buffer_store_dwordx4 v[12:15], v2, s[16:19], s34 offen sc1
  s_waitcnt vmcnt(0)
  s_mov_b64 exec, 1
  v_mov_b32 v8, 0x10000
  buffer_atomic_add v8, off, s[20:23], s7
  s_mov_b64 exec, -1
  s_branch L_slowret
L_spin1:
  v_mov_b32 v8, 0
  buffer_atomic_add v8, off, s[20:23], s7 sc0
  s_waitcnt vmcnt(0)
  v_readfirstlane_b32 s5, v8
L_spin2:
  s_cmp_ge_u32 s5, 0x10000
  s_cbranch_scc0 L_spin1
  s_mov_b64 exec, -1
  s_branch L_slowret
L_mon:
  s_getreg_b32 s32, hwreg(HW_REG_XCC_ID, 0, 4)
  s_mul_i32 s32, s32, 4352
  s_getreg_b32 s35, hwreg(HW_REG_HW_ID, 8, 4)
  s_getreg_b32 s7, hwreg(HW_REG_HW_ID, 13, 2)
  s_lshl_b32 s7, s7, 4
  s_add_u32 s35, s35, s7
  v_lshlrev_b32 v11, 2, v0
  v_mul_u32_u24 v14, 4352, v0
  v_add_u32 v14, 69632, v14
  v_mov_b32 v15, 1
  s_waitcnt lgkmcnt(0)
  s_add_u32 s20, s50, 4194304
  s_addc_u32 s21, s51, 0
  s_mov_b32 s22, 348160
  s_mov_b32 s23, 0x20000
  buffer_load_dword v9, v11, s[20:23], s32 offen
  s_barrier
  s_barrier
  s_barrier
  s_barrier
  s_barrier
  s_barrier
  s_barrier
  s_barrier
  s_barrier
  s_barrier
  buffer_load_dword v10, v11, s[20:23], s32 offen
  s_barrier
  s_waitcnt vmcnt(0)
  v_cmp_ne_u32 vcc, v10, v9
  v_readlane_b32 s26, v9, 15
  s_ff1_i32_b64 s7, vcc
  s_cmp_lg_u32 s7, s35
  s_cbranch_scc1 L_end
  buffer_load_dword v12, v14, s[20:23], 0 offen sc1
  s_barrier
  s_barrier
  s_waitcnt vmcnt(0)
  s_mov_b32 s33, 0
  v_readfirstlane_b32 s27, v12
  s_mov_b32 s34, 69632
  s_mov_b64 exec, 1
L_ml:
  v_mov_b32 v13, 1
  v_readlane_b32 s27, v12, s33
  s_barrier
  buffer_atomic_add v13, off, s[20:23], s34 sc0 sc1
  s_add_u32 s34, s34, 4352
  s_barrier
  s_waitcnt vmcnt(0)
  v_readfirstlane_b32 s7, v13
  s_sub_u32 s7, s7, s27
  s_add_u32 s7, s7, 8
  s_max_i32 s7, s7, 4
  s_min_i32 s7, s7, 19
  s_mul_i32 s7, s7, 4
  s_addk_i32 s7, -46
  s_ashr_i32 s7, s7, 1
  s_add_u32 s7, s7, s26
  v_mov_b32 v17, s7
  s_mov_b64 exec, 1
  buffer_store_dword v17, off, s[20:23], s32 offset:60
  s_barrier
  s_barrier
  s_add_u32 s33, s33, 1
  s_cmp_lt_u32 s33, 19
  s_cbranch_scc1 L_ml
  s_endpgm
L_qfb:
  s_waitcnt lgkmcnt(0)
  v_mul_u32_u24 v3, 0x3000, v1
  v_lshl_add_u32 v3, v2, 4, v3
  v_lshlrev_b32 v34, 1, v1
  s_mul_i32 s7, s4, 1280
  s_mul_i32 s34, s3, 160
  s_add_u32 s7, s7, s34
  s_mul_i32 s34, s3, 983040
  s_mul_i32 s35, s5, 384
  s_add_u32 s34, s34, s35
  v_mov_b32 v12, 0
  v_mov_b32 v13, 0
  v_mov_b32 v14, 0
  v_mov_b32 v15, 0
  v_mov_b32 v16, 0
  v_mov_b32 v17, 0
  v_mov_b32 v18, 0
  v_mov_b32 v19, 0
  v_mov_b32 v20, 0
  v_mov_b32 v21, 0
  v_mov_b32 v22, 0
  v_mov_b32 v23, 0
  s_mov_b32 s35, 5
L_qf1:
  buffer_load_ushort v36, v34, s[12:15], s7 offen offset:0
  buffer_load_ushort v37, v34, s[12:15], s7 offen offset:16
  buffer_load_dwordx4 v[48:51], v3, s[8:11], s34 offen offset:0
  buffer_load_dwordx4 v[52:55], v3, s[8:11], s34 offen offset:128
  buffer_load_dwordx4 v[56:59], v3, s[8:11], s34 offen offset:256
  s_add_u32 s34, s34, 98304
  buffer_load_dwordx4 v[60:63], v3, s[8:11], s34 offen offset:0
  buffer_load_dwordx4 v[64:67], v3, s[8:11], s34 offen offset:128
  buffer_load_dwordx4 v[68:71], v3, s[8:11], s34 offen offset:256
  s_add_u32 s34, s34, 98304
  s_add_u32 s7, s7, 32
  s_waitcnt vmcnt(0)
  v_mul_u32_u24_sdwa v8, v36, v4 dst_sel:DWORD dst_unused:UNUSED_PAD src0_sel:WORD_0 src1_sel:DWORD
  v_mul_u32_u24_sdwa v9, v36, v5 dst_sel:DWORD dst_unused:UNUSED_PAD src0_sel:WORD_0 src1_sel:DWORD
  v_mul_u32_u24_sdwa v10, v36, v6 dst_sel:DWORD dst_unused:UNUSED_PAD src0_sel:WORD_0 src1_sel:DWORD
  v_mul_u32_u24_sdwa v11, v36, v7 dst_sel:DWORD dst_unused:UNUSED_PAD src0_sel:WORD_0 src1_sel:DWORD
  s_nop 1
  v_mfma_f32_16x16x32_bf16 v[12:15], v[48:51], v[8:11], v[12:15]
  v_mfma_f32_16x16x32_bf16 v[16:19], v[52:55], v[8:11], v[16:19]
  v_mfma_f32_16x16x32_bf16 v[20:23], v[56:59], v[8:11], v[20:23]
  s_nop 7
  s_nop 7
  v_mul_u32_u24_sdwa v8, v37, v4 dst_sel:DWORD dst_unused:UNUSED_PAD src0_sel:WORD_0 src1_sel:DWORD
  v_mul_u32_u24_sdwa v9, v37, v5 dst_sel:DWORD dst_unused:UNUSED_PAD src0_sel:WORD_0 src1_sel:DWORD
  v_mul_u32_u24_sdwa v10, v37, v6 dst_sel:DWORD dst_unused:UNUSED_PAD src0_sel:WORD_0 src1_sel:DWORD
  v_mul_u32_u24_sdwa v11, v37, v7 dst_sel:DWORD dst_unused:UNUSED_PAD src0_sel:WORD_0 src1_sel:DWORD
  s_nop 1
  v_mfma_f32_16x16x32_bf16 v[12:15], v[60:63], v[8:11], v[12:15]
  v_mfma_f32_16x16x32_bf16 v[16:19], v[64:67], v[8:11], v[16:19]
  v_mfma_f32_16x16x32_bf16 v[20:23], v[68:71], v[8:11], v[20:23]
  s_nop 7
  s_nop 7
  s_sub_u32 s35, s35, 1
  s_cmp_lg_u32 s35, 0
  s_cbranch_scc1 L_qf1
  v_bfe_u32 v37, v0, 4, 1
  v_lshlrev_b32 v37, 7, v37
  v_lshl_add_u32 v37, v2, 4, v37
  s_mul_i32 s7, s3, 768
  s_add_u32 s7, s7, 155648
  v_add_u32 v37, s7, v37
  s_mov_b32 exec_lo, s32
  s_mov_b32 exec_hi, 0
  ds_write_b128 v37, v[12:15] offset:0
  ds_write_b128 v37, v[16:19] offset:256
  ds_write_b128 v37, v[20:23] offset:512
  s_waitcnt lgkmcnt(0)
  s_mov_b32 exec_lo, 0
  s_mov_b32 exec_hi, s33
  ds_add_f32 v37, v12 offset:0
  ds_add_f32 v37, v13 offset:4
  ds_add_f32 v37, v14 offset:8
  ds_add_f32 v37, v15 offset:12
  ds_add_f32 v37, v16 offset:256
  ds_add_f32 v37, v17 offset:260
  ds_add_f32 v37, v18 offset:264
  ds_add_f32 v37, v19 offset:268
  ds_add_f32 v37, v20 offset:512
  ds_add_f32 v37, v21 offset:516
  ds_add_f32 v37, v22 offset:520
  ds_add_f32 v37, v23 offset:524
  s_mov_b32 exec_lo, -1
  s_mov_b32 exec_hi, 0xffff
  s_waitcnt lgkmcnt(0)
  s_barrier
  v_add_u32 v38, 155648, v39
  ds_read_b128 v[40:43], v38 offset:0
  ds_read_b128 v[44:47], v38 offset:768
  ds_read_b128 v[48:51], v38 offset:1536
  ds_read_b128 v[52:55], v38 offset:2304
  ds_read_b128 v[56:59], v38 offset:3072
  ds_read_b128 v[60:63], v38 offset:3840
  ds_read_b128 v[64:67], v38 offset:4608
  ds_read_b128 v[68:71], v38 offset:5376
  v_lshlrev_b32 v30, 6, v1
  v_lshl_add_u32 v30, v2, 1, v30
  v_add_u32 v30, 161792, v30
  s_waitcnt lgkmcnt(0)
  v_add_f32 v40, v40, v44
  v_add_f32 v41, v41, v45
  v_add_f32 v42, v42, v46
  v_add_f32 v43, v43, v47
  v_add_f32 v48, v48, v52
  v_add_f32 v49, v49, v53
  v_add_f32 v50, v50, v54
  v_add_f32 v51, v51, v55
  v_add_f32 v56, v56, v60
  v_add_f32 v57, v57, v61
  v_add_f32 v58, v58, v62
  v_add_f32 v59, v59, v63
  v_add_f32 v64, v64, v68
  v_add_f32 v65, v65, v69
  v_add_f32 v66, v66, v70
  v_add_f32 v67, v67, v71
  v_add_f32 v40, v40, v48
  v_add_f32 v41, v41, v49
  v_add_f32 v42, v42, v50
  v_add_f32 v43, v43, v51
  v_add_f32 v56, v56, v64
  v_add_f32 v57, v57, v65
  v_add_f32 v58, v58, v66
  v_add_f32 v59, v59, v67
  v_add_f32 v40, v40, v56
  v_add_f32 v41, v41, v57
  v_add_f32 v42, v42, v58
  v_add_f32 v43, v43, v59
  v_cvt_pk_bf16_f32 v40, v40, v41
  v_cvt_pk_bf16_f32 v41, v42, v43
  ds_write_b16 v30, v40
  ds_write_b16_d16_hi v30, v40 offset:16
  ds_write_b16 v30, v41 offset:32
  ds_write_b16_d16_hi v30, v41 offset:48
  s_mov_b64 exec, -1
  v_mov_b32 v45, 0
  s_mov_b32 s69, 1
  s_waitcnt lgkmcnt(0)
  s_branch L_qjoin
.section .rodata,"a"
.p2align 6
.amdhsa_kernel standalone__gqa_block_cached__decode_kernel
  .amdhsa_next_free_vgpr 168
  .amdhsa_next_free_sgpr 96
  .amdhsa_accum_offset 168
  .amdhsa_group_segment_fixed_size 0
  .amdhsa_kernarg_size 64
  .amdhsa_user_sgpr_count 2
  .amdhsa_user_sgpr_kernarg_segment_ptr 1
  .amdhsa_system_sgpr_workgroup_id_x 1
.end_amdhsa_kernel
```
